```python
import torch

def _softmax(x, axis=-1):
    return torch.softmax(x, dim=axis)
def _gelu(x):
    return torch.nn.functional.gelu(x, approximate="tanh")
def _silu(x):
    return torch.nn.functional.silu(x)
def _sigmoid(x):
    return torch.sigmoid(x)
def _layernorm(x, axis=-1, eps=1e-5):
    m = x.mean(dim=axis, keepdim=True)
    v = x.var(dim=axis, keepdim=True, unbiased=False)
    return (x - m) / torch.sqrt(v + eps)
def _scatter_add(tgt, idx, src, axis=0):
    return tgt.clone().index_add_(axis, idx, src)
def _segment_sum(src, seg, n):
    out = torch.zeros((n,) + src.shape[1:], dtype=src.dtype)
    return out.index_add_(0, seg, src)
def _pad(x, pw):
    flat = tuple(v for pair in reversed(pw) for v in pair)
    return torch.nn.functional.pad(x, flat)

kernel_name = 'recurrent_scan__spectral_gfnet__dense_activation_silu__prompt'

def setup_inputs():

    _w = (lambda a: (lambda t: t.to(torch.bfloat16) if t.is_floating_point() else t)(torch.as_tensor(a)))
    def _A_setup():
        B, S, D = 1, 2048, 512
        Df = D // 2 + 1
        return {
            "x": _w((lambda *s: torch.randn(*s, dtype=torch.bfloat16) * 0.05)(B, S, D)),
            "w_r": _w((lambda *s: torch.randn(*s, dtype=torch.bfloat16) * 3.2)(S, Df) * 0.02),
            "w_i": _w((lambda *s: torch.randn(*s, dtype=torch.bfloat16) * 3.2)(S, Df) * 0.02),
        }
    _A_in = _A_setup()

    def _B_setup():
        B, S, D, F = 1, 2048, 512, 1792
        return {
            "x": _w((lambda *s: torch.randn(*s, dtype=torch.bfloat16) * 0.05)(B, S, D)),
            "w1": _w((lambda *s: torch.randn(*s, dtype=torch.bfloat16) * 3.2)(D, F) * (D ** -0.5)),
            "w2": _w((lambda *s: torch.randn(*s, dtype=torch.bfloat16) * 0.4)(F, D) * (F ** -0.5)),
        }
    _B_in = _B_setup()

    return {
        "A_x": _A_in["x"],
        "A_w_r": _A_in["w_r"],
        "A_w_i": _A_in["w_i"],
        "B_x": _B_in["x"],
        "B_w1": _B_in["w1"],
        "B_w2": _B_in["w2"],
    }

def reference(A_x, A_w_r, A_w_i, B_x, B_w1, B_w2):
    def _A_ref(x, w_r, w_i):
        B, S, D = x.shape
        X = (lambda x, axes=(-2,-1): torch.fft.rfft2(x.float(), dim=axes))(x, axes=(-2, -1))
        W = w_r + 1j * w_i
        X = X * W
        y = (lambda x, s, axes=(-2,-1): torch.fft.irfft2(x, s=s, dim=axes).to(torch.bfloat16))(X, (S, D), axes=(-2, -1))
        return y

    def _B_ref(x, w1, w2):
        h = torch.einsum("bsd,df->bsf", x, w1)
        h = _silu(h)
        out = torch.einsum("bsf,fd->bsd", h, w2)
        return out

    x = A_x
    xn = _layernorm(x, axis=-1)
    s = _A_ref(xn, A_w_r, A_w_i)
    g = _silu(_B_ref(xn, B_w1, B_w2))
    return x + s * g
```

```asm
; @launch grid=(256,1,1) block=(256,1,1) lds=163840
.amdgcn_target "amdgcn-amd-amdhsa--gfx950"
.text
.globl recurrent_scan__spectral_gfnet__dense_activation_silu__prompt_kernel
.p2align 8
.type recurrent_scan__spectral_gfnet__dense_activation_silu__prompt_kernel,@function
recurrent_scan__spectral_gfnet__dense_activation_silu__prompt_kernel:
    s_getpc_b64 s[50:51]
    s_load_dwordx4 s[44:47], s[0:1], 0
    s_and_b32 s3, s2, 0xf8
    v_min_u32 v5, 7, v0
    v_add_lshl_u32 v5, s3, v5, 7
    v_min_u32 v5, L_end-recurrent_scan__spectral_gfnet__dense_activation_silu__prompt_kernel-8, v5
    s_mov_b64 exec, 0xff
    global_load_dword a203, v5, s[50:51]
    s_mov_b64 exec, -1
    s_load_dwordx2 s[48:49], s[0:1], 16
    s_load_dwordx4 s[52:55], s[0:1], 32
    s_load_dwordx4 s[56:59], s[0:1], 48
    s_load_dwordx2 s[60:61], s[0:1], 64
    s_memrealtime s[62:63]
    s_cmp_ge_u32 s2, 256
    s_cbranch_scc1 L_end
    v_and_b32 v1, 63, v0
    v_lshrrev_b32 v4, 6, v0
    v_and_b32 v2, 15, v0
    v_bfe_u32 v3, v0, 4, 2
    v_readfirstlane_b32 s36, v4
    v_lshlrev_b32 v4, 4, v1
    v_mov_b32 v254, 0
    s_and_b32 s37, s2, 7
    s_lshl_b32 s37, s37, 2
    s_bfe_u32 s38, s2, 0x20003
    s_add_u32 s37, s37, s38
    s_and_b32 s39, s37, 15
    s_lshr_b32 s38, s2, 5
    s_bfe_u32 s40, s2, 0x10002
    s_lshl_b32 s40, s40, 3
    s_add_u32 s40, s40, s38
    s_add_u32 s41, s39, s40
    s_and_b32 s41, s41, 7
    v_lshrrev_b32 v5, 3, v1
    v_and_b32 v6, 7, v1
    v_xor_b32 v0, v6, v3
    v_lshlrev_b32 v0, 4, v0
    v_lshl_add_u32 v248, v5, 15, v0
    s_and_b32 s50, s36, 1
    s_lshl_b32 s50, s50, 20
    s_lshl_b32 s42, s39, 1
    s_lshr_b32 s51, s36, 1
    s_add_u32 s42, s42, s51
    s_lshl_b32 s51, s42, 10
    s_add_u32 s50, s50, s51
    v_add_u32 v248, s50, v248
    v_xor_b32 v249, 64, v248
    v_add_u32 v249, 0x3fc00, v249
    v_add_u32 v250, 0x7f800, v248
    v_add_u32 v251, 0x7f800, v249
    s_lshl_b32 s43, s41, 7
    s_waitcnt lgkmcnt(0)
    s_mov_b32 s4, s44
    s_mov_b32 s5, s45
    s_mov_b32 s6, 0x200000
    s_mov_b32 s7, 0x00020000
    s_lshl_b32 s44, s36, 12
    s_add_u32 m0, s44, 131072
    s_nop 0
    buffer_load_dwordx4 v248, s[4:7], s43 offen offset:0 lds
    buffer_load_dwordx4 v249, s[4:7], s43 offen offset:1024 lds
    buffer_load_dwordx4 v250, s[4:7], s43 offen offset:2048 lds
    buffer_load_dwordx4 v251, s[4:7], s43 offen offset:3072 lds
    s_add_u32 m0, s44, 147456
    s_add_u32 s43, s43, 0x80
    s_and_b32 s43, s43, 0x3ff
    buffer_load_dwordx4 v248, s[4:7], s43 offen offset:0 lds
    buffer_load_dwordx4 v249, s[4:7], s43 offen offset:1024 lds
    buffer_load_dwordx4 v250, s[4:7], s43 offen offset:2048 lds
    buffer_load_dwordx4 v251, s[4:7], s43 offen offset:3072 lds
    s_add_u32 m0, s44, 16384
    s_add_u32 s43, s43, 0x80
    s_and_b32 s43, s43, 0x3ff
    buffer_load_dwordx4 v248, s[4:7], s43 offen offset:0 lds
    s_lshl_b32 s50, s40, 5
    s_and_b32 s51, s36, 1
    s_lshl_b32 s3, s51, 4
    s_add_u32 s50, s50, s3
    v_add_u32 v11, s50, v2
    v_lshrrev_b32 v12, 1, v11
    v_cmp_eq_u32 vcc, 0, v12
    v_mov_b32 v13, 0x100
    s_nop 0
    v_cndmask_b32 v12, v12, v13, vcc
    v_cvt_f32_u32 v13, v12
    v_mul_f32 v13, 0x3b000000, v13
    v_and_b32 v14, 1, v11
    v_cvt_f32_u32 v14, v14
    v_mul_f32 v14, 0.25, v14
    s_lshr_b32 s50, s36, 1
    s_lshl_b32 s3, s50, 1
    s_add_u32 s3, s3, s41
    s_lshl_b32 s3, s3, 6
    v_lshl_add_u32 v15, v3, 3, s3
    v_cvt_f32_u32 v15, v15
    v_fma_f32 v14, v15, v13, v14
    v_fract_f32 v14, v14
    s_lshl_b32 s50, s50, 13
    s_lshl_b32 s51, s51, 10
    s_add_u32 s50, s50, s51
    s_add_u32 s50, s50, 114688
    v_add_u32 v11, s50, v4
    v_mul_f32 v15, 0x41c80000, v13
    s_mov_b32 s16, s52
    s_mov_b32 s17, s53
    s_mov_b32 s18, 0x1c0000
    s_mov_b32 s19, 0x00020000
    s_lshl_b32 s50, s2, 2
    s_add_u32 s50, s50, s36
    s_mul_i32 s50, s50, 1792
    v_lshl_add_u32 v7, v1, 7, s50
    v_mov_b32 v9, 0x7ff00000
    v_cmp_gt_u32 vcc, 14, v1
    s_nop 1
    v_cndmask_b32 v7, v9, v7, vcc
    buffer_load_dword a201, v7, s[16:19], 0 offen
    s_mov_b32 s8, s46
    s_mov_b32 s9, s47
    s_mov_b32 s10, 0x101000
    s_mov_b32 s11, 0x00020000
    s_mov_b32 s12, s48
    s_mov_b32 s13, s49
    s_mov_b32 s14, 0x101000
    s_mov_b32 s15, 0x00020000
    s_mov_b32 s20, s54
    s_mov_b32 s21, s55
    s_mov_b32 s22, 0x1c0000
    s_mov_b32 s23, 0x00020000
    s_mov_b32 s24, s60
    s_mov_b32 s25, s61
    s_mov_b32 s26, 0x10000000
    s_mov_b32 s27, 0x00020000
    s_mov_b32 s28, s56
    s_mov_b32 s29, s57
    s_mov_b32 s30, 0x200000
    s_mov_b32 s31, 0x00020000
    s_mov_b32 s32, s58
    s_mov_b32 s33, s59
    s_mov_b32 s34, 0x100
    s_mov_b32 s35, 0x00020000
    s_or_b32 s62, s62, 1
    v_mov_b32 v255, s62
    s_or_b32 s46, s2, s36
    s_cmp_eq_u32 s46, 0
    s_cselect_b32 s46, 0, 0x100
    s_mov_b64 exec, 1
    buffer_store_dword v255, v254, s[32:35], s46 offen sc1
    s_mov_b64 exec, -1
    v_cos_f32 v136, v14
    v_add_f32 v14, v14, v13
    v_cos_f32 v137, v14
    v_add_f32 v14, v14, v13
    v_cos_f32 v138, v14
    v_add_f32 v14, v14, v13
    v_cos_f32 v139, v14
    v_add_f32 v14, v14, v13
    v_cos_f32 v140, v14
    v_add_f32 v14, v14, v13
    v_cos_f32 v141, v14
    v_add_f32 v14, v14, v13
    v_cos_f32 v142, v14
    v_add_f32 v14, v14, v13
    v_cos_f32 v143, v14
    v_add_f32 v14, v14, v15
    v_cvt_pk_bf16_f32 v144, v136, v137
    v_cvt_pk_bf16_f32 v145, v138, v139
    v_cvt_pk_bf16_f32 v146, v140, v141
    v_cvt_pk_bf16_f32 v147, v142, v143
    ds_write_b128 v11, v[144:147] offset:0
    v_cos_f32 v148, v14
    v_add_f32 v14, v14, v13
    v_cos_f32 v149, v14
    v_add_f32 v14, v14, v13
    v_cos_f32 v150, v14
    v_add_f32 v14, v14, v13
    v_cos_f32 v151, v14
    v_add_f32 v14, v14, v13
    v_cos_f32 v152, v14
    v_add_f32 v14, v14, v13
    v_cos_f32 v153, v14
    v_add_f32 v14, v14, v13
    v_cos_f32 v154, v14
    v_add_f32 v14, v14, v13
    v_cos_f32 v155, v14
    v_add_f32 v14, v14, v15
    v_cvt_pk_bf16_f32 v156, v148, v149
    v_cvt_pk_bf16_f32 v157, v150, v151
    v_cvt_pk_bf16_f32 v158, v152, v153
    v_cvt_pk_bf16_f32 v159, v154, v155
    ds_write_b128 v11, v[156:159] offset:2048
    v_cos_f32 v136, v14
    v_add_f32 v14, v14, v13
    v_cos_f32 v137, v14
    v_add_f32 v14, v14, v13
    v_cos_f32 v138, v14
    v_add_f32 v14, v14, v13
    v_cos_f32 v139, v14
    v_add_f32 v14, v14, v13
    v_cos_f32 v140, v14
    v_add_f32 v14, v14, v13
    v_cos_f32 v141, v14
    v_add_f32 v14, v14, v13
    v_cos_f32 v142, v14
    v_add_f32 v14, v14, v13
    v_cos_f32 v143, v14
    v_add_f32 v14, v14, v15
    v_cvt_pk_bf16_f32 v144, v136, v137
    v_cvt_pk_bf16_f32 v145, v138, v139
    v_cvt_pk_bf16_f32 v146, v140, v141
    v_cvt_pk_bf16_f32 v147, v142, v143
    ds_write_b128 v11, v[144:147] offset:4096
    v_cos_f32 v148, v14
    v_add_f32 v14, v14, v13
    v_cos_f32 v149, v14
    v_add_f32 v14, v14, v13
    v_cos_f32 v150, v14
    v_add_f32 v14, v14, v13
    v_cos_f32 v151, v14
    v_add_f32 v14, v14, v13
    v_cos_f32 v152, v14
    v_add_f32 v14, v14, v13
    v_cos_f32 v153, v14
    v_add_f32 v14, v14, v13
    v_cos_f32 v154, v14
    v_add_f32 v14, v14, v13
    v_cos_f32 v155, v14
    v_cvt_pk_bf16_f32 v156, v148, v149
    v_cvt_pk_bf16_f32 v157, v150, v151
    v_cvt_pk_bf16_f32 v158, v152, v153
    v_cvt_pk_bf16_f32 v159, v154, v155
    ds_write_b128 v11, v[156:159] offset:6144
    s_and_b32 s46, s36, 1
    s_lshr_b32 s47, s36, 1
    s_lshl_b32 s47, s47, 2
    s_add_u32 s46, s46, s47
    s_lshl_b32 s47, s46, 6
    s_lshl_b32 s46, s46, 10
    s_mul_i32 s48, s40, 224
    s_cmp_eq_u32 s36, 3
    s_movk_i32 s45, 0x800
    s_cmov_b32 s45, 0x30000
    s_cselect_b32 s49, 0x7ff00000, s48
    s_mul_i32 s61, s41, 229376
    v_add_u32 v7, s47, v1
    v_mul_u32_u24 v8, 4682, v7
    v_lshrrev_b32 v8, 16, v8
    v_mad_i32_i24 v7, v8, -14, v7
    v_and_b32 v9, 12, v8
    v_and_b32 v10, 3, v8
    v_lshl_add_u32 v9, v9, 1, v10
    v_lshrrev_b32 v10, 4, v8
    v_lshl_add_u32 v9, v10, 2, v9
    v_mul_u32_u24 v9, 3584, v9
    v_lshl_add_u32 v9, v7, 4, v9
    v_add_u32 v252, s48, v9
    v_add_u32 v7, s47, v1
    v_add_u32 v7, 0x80, v7
    v_mul_u32_u24 v8, 4682, v7
    v_lshrrev_b32 v8, 16, v8
    v_mad_i32_i24 v7, v8, -14, v7
    v_and_b32 v9, 12, v8
    v_and_b32 v10, 3, v8
    v_lshl_add_u32 v9, v9, 1, v10
    v_lshrrev_b32 v10, 4, v8
    v_lshl_add_u32 v9, v10, 2, v9
    v_mul_u32_u24 v9, 3584, v9
    v_lshl_add_u32 v9, v7, 4, v9
    v_add_u32 v253, s49, v9
    s_waitcnt lgkmcnt(0)
    s_barrier
    v_add_u32 v10, 114688, v4
    ds_read_b128 a[128:131], v10 offset:0
    ds_read_b128 a[132:135], v10 offset:1024
    ds_read_b128 a[136:139], v10 offset:2048
    ds_read_b128 a[140:143], v10 offset:3072
    ds_read_b128 a[144:147], v10 offset:4096
    ds_read_b128 a[148:151], v10 offset:5120
    ds_read_b128 a[152:155], v10 offset:6144
    ds_read_b128 a[156:159], v10 offset:7168
    ds_read_b128 a[160:163], v10 offset:8192
    ds_read_b128 a[164:167], v10 offset:9216
    ds_read_b128 a[168:171], v10 offset:10240
    ds_read_b128 a[172:175], v10 offset:11264
    ds_read_b128 a[176:179], v10 offset:12288
    ds_read_b128 a[180:183], v10 offset:13312
    ds_read_b128 a[184:187], v10 offset:14336
    ds_read_b128 a[188:191], v10 offset:15360
    s_lshr_b32 s47, s37, 2
    s_lshl_b32 s47, s47, 8
    s_and_b32 s48, s37, 3
    s_lshl_b32 s48, s48, 4
    s_add_u32 s47, s47, s48
    s_lshl_b32 s48, s36, 2
    s_add_u32 s47, s47, s48
    v_bfe_u32 v14, v1, 2, 2
    v_lshl_add_u32 v14, v14, 6, s47
    v_add_u32 v14, v14, v3
    v_mul_u32_u24 v14, 514, v14
    v_and_b32 v8, 3, v1
    s_lshl_b32 s47, s38, 6
    s_add_u32 s47, s47, 2
    v_lshl_add_u32 v9, v8, 4, s47
    v_add_u32 v14, v14, v9
    s_lshl_b32 s47, s2, 2
    s_add_u32 s47, s47, s36
    s_mul_i32 s47, s47, 1792
    v_lshl_add_u32 v15, v1, 7, s47
    v_mov_b32 v9, 0x7ff00000
    v_cmp_gt_u32 vcc, 14, v1
    s_nop 1
    v_cndmask_b32 v15, v9, v15, vcc
    v_lshrrev_b32 v7, 2, v1
    v_mul_u32_u24 v7, 224, v7
    v_lshl_add_u32 v5, v8, 3, v7
    v_add_u32 v6, 57344, v5
    v_lshrrev_b32 v13, 1, v2
    v_xor_b32 v13, v13, v3
    v_lshlrev_b32 v13, 4, v13
    v_lshl_add_u32 v13, v2, 7, v13
    v_add_u32 v7, s44, v13
    v_xor_b32 v8, 64, v7
    v_add_u32 v9, 0x10000, v7
    v_add_u32 v10, 0x10000, v8
    v_add_u32 v11, 0x20000, v7
    v_add_u32 v12, 0x20000, v8
    v_mov_b32 v228, 0x3f803f80
    v_mov_b32 v229, 0x3f803f80
    v_mov_b32 v230, 0x3f803f80
    v_mov_b32 v231, 0x3f803f80
    s_lshl_b32 s47, s36, 4
    v_add_u32 v80, s47, v2
    v_cvt_f32_u32 v81, v80
    v_mul_f32 v82, 0x3c800000, v81
    v_lshlrev_b32 v83, 2, v3
    v_cvt_f32_u32 v85, v83
    v_mul_f32 v83, v85, v82
    v_add_f32 v83, v83, v83
    v_and_b32 v86, 1, v2
    v_mul_u32_u24 v86, 0x8000, v86
    v_lshl_or_b32 v86, v86, 16, v86
    v_cos_f32 v136, v83
    v_sin_f32 v144, v83
    v_add_f32 v83, v83, v82
    v_cos_f32 v137, v83
    buffer_load_dwordx4 v249, s[4:7], s43 offen offset:1024 lds
    v_sin_f32 v145, v83
    v_add_f32 v83, v83, v82
    v_cos_f32 v138, v83
    v_sin_f32 v146, v83
    v_add_f32 v83, v83, v82
    v_cos_f32 v139, v83
    v_sin_f32 v147, v83
    v_add_f32 v83, v83, v82
    v_cos_f32 v140, v83
    v_sin_f32 v148, v83
    v_add_f32 v83, v83, v82
    buffer_load_dwordx4 v250, s[4:7], s43 offen offset:2048 lds
    v_cos_f32 v141, v83
    v_sin_f32 v149, v83
    v_add_f32 v83, v83, v82
    v_cos_f32 v142, v83
    v_sin_f32 v150, v83
    v_add_f32 v83, v83, v82
    v_cos_f32 v143, v83
    v_sin_f32 v151, v83
    v_cvt_pk_bf16_f32 v16, v136, v137
    v_cvt_pk_bf16_f32 v24, v144, v145
    v_xor_b32 v32, 0x80008000, v24
    v_xor_b32 v20, v86, v16
    buffer_load_dwordx4 v251, s[4:7], s43 offen offset:3072 lds
    v_xor_b32 v28, v86, v24
    v_xor_b32 v36, v86, v32
    v_cvt_pk_bf16_f32 v17, v138, v139
    v_cvt_pk_bf16_f32 v25, v146, v147
    v_xor_b32 v33, 0x80008000, v25
    v_xor_b32 v21, v86, v17
    v_xor_b32 v29, v86, v25
    v_xor_b32 v37, v86, v33
    v_cvt_pk_bf16_f32 v18, v140, v141
    v_cvt_pk_bf16_f32 v26, v148, v149
    v_xor_b32 v34, 0x80008000, v26
    v_xor_b32 v22, v86, v18
    v_xor_b32 v30, v86, v26
    v_xor_b32 v38, v86, v34
    v_cvt_pk_bf16_f32 v19, v142, v143
    v_cvt_pk_bf16_f32 v27, v150, v151
    v_xor_b32 v35, 0x80008000, v27
    v_xor_b32 v23, v86, v19
    s_add_u32 m0, s44, 32768
    s_add_u32 s43, s43, 0x80
    s_and_b32 s43, s43, 0x3ff
    buffer_load_dwordx4 v248, s[4:7], s43 offen offset:0 lds
    v_xor_b32 v31, v86, v27
    v_xor_b32 v39, v86, v35
    v_mul_f32 v82, 0x3a000000, v81
    v_mul_f32 v83, v85, v82
    v_mul_f32 v84, 0x41500000, v82
    v_cos_f32 v64, v83
    v_sin_f32 v72, v83
    v_add_f32 v83, v83, v82
    v_cos_f32 v65, v83
    v_sin_f32 v73, v83
    v_add_f32 v83, v83, v82
    v_cos_f32 v66, v83
    v_sin_f32 v74, v83
    buffer_load_dwordx4 v249, s[4:7], s43 offen offset:1024 lds
    v_add_f32 v83, v83, v82
    v_cos_f32 v67, v83
    v_sin_f32 v75, v83
    v_add_f32 v83, v83, v84
    v_cos_f32 v68, v83
    v_sin_f32 v76, v83
    v_add_f32 v83, v83, v82
    v_cos_f32 v69, v83
    v_sin_f32 v77, v83
    v_add_f32 v83, v83, v82
    v_cos_f32 v70, v83
    buffer_load_dwordx4 v250, s[4:7], s43 offen offset:2048 lds
    v_sin_f32 v78, v83
    v_add_f32 v83, v83, v82
    v_cos_f32 v71, v83
    v_sin_f32 v79, v83
    v_cvt_f32_u32 v82, v2
    v_mul_f32 v82, 0x3d000000, v82
    v_mul_f32 v83, v85, v82
    v_mul_f32 v84, 0x41500000, v82
    v_cos_f32 v136, v83
    v_sin_f32 v144, v83
    v_add_f32 v83, v83, v82
    v_cos_f32 v137, v83
    buffer_load_dwordx4 v251, s[4:7], s43 offen offset:3072 lds
    v_sin_f32 v145, v83
    v_add_f32 v83, v83, v82
    v_cos_f32 v138, v83
    v_sin_f32 v146, v83
    v_add_f32 v83, v83, v82
    v_cos_f32 v139, v83
    v_sin_f32 v147, v83
    v_add_f32 v83, v83, v84
    v_cos_f32 v140, v83
    v_sin_f32 v148, v83
    v_add_f32 v83, v83, v82
    s_add_u32 m0, s44, 49152
    s_add_u32 s43, s43, 0x80
    s_and_b32 s43, s43, 0x3ff
    buffer_load_dwordx4 v248, s[4:7], s43 offen offset:0 lds
    v_cos_f32 v141, v83
    v_sin_f32 v149, v83
    v_add_f32 v83, v83, v82
    v_cos_f32 v142, v83
    v_sin_f32 v150, v83
    v_add_f32 v83, v83, v82
    v_cos_f32 v143, v83
    v_sin_f32 v151, v83
    v_cvt_pk_bf16_f32 v40, v136, v137
    v_cvt_pk_bf16_f32 v48, v144, v145
    v_xor_b32 v56, 0x80008000, v48
    v_xor_b32 v44, 0x80000000, v40
    buffer_load_dwordx4 v249, s[4:7], s43 offen offset:1024 lds
    v_xor_b32 v52, 0x80000000, v48
    v_xor_b32 v60, 0x80000000, v56
    v_cvt_pk_bf16_f32 v41, v138, v139
    v_cvt_pk_bf16_f32 v49, v146, v147
    v_xor_b32 v57, 0x80008000, v49
    v_xor_b32 v45, 0x80000000, v41
    v_xor_b32 v53, 0x80000000, v49
    v_xor_b32 v61, 0x80000000, v57
    v_cvt_pk_bf16_f32 v42, v140, v141
    v_cvt_pk_bf16_f32 v50, v148, v149
    v_xor_b32 v58, 0x80008000, v50
    v_xor_b32 v46, 0x80000000, v42
    v_xor_b32 v54, 0x80000000, v50
    v_xor_b32 v62, 0x80000000, v58
    v_cvt_pk_bf16_f32 v43, v142, v143
    v_cvt_pk_bf16_f32 v51, v150, v151
    v_xor_b32 v59, 0x80008000, v51
    v_xor_b32 v47, 0x80000000, v43
    buffer_load_dwordx4 v250, s[4:7], s43 offen offset:2048 lds
    v_xor_b32 v55, 0x80000000, v51
    v_xor_b32 v63, 0x80000000, v59
    s_waitcnt vmcnt(17)
    ds_read_b128 a[0:3], v11 offset:0
    ds_read_b128 a[64:67], v11 offset:2048
    ds_read_b128 a[4:7], v12 offset:0
    ds_read_b128 a[68:71], v12 offset:2048
    s_waitcnt vmcnt(13)
    ds_read_b128 a[8:11], v11 offset:16384
    ds_read_b128 a[72:75], v11 offset:18432
    ds_read_b128 a[12:15], v12 offset:16384
    ds_read_b128 a[76:79], v12 offset:18432
    s_waitcnt lgkmcnt(4)
    v_mfma_f32_16x16x32_bf16 v[232:235], v[228:231], a[0:3], 0
    s_lshl_b32 s47, s36, 5
    v_mfma_f32_16x16x32_bf16 v[240:243], a[0:3], a[0:3], 0
    s_add_u32 s58, s47, 0x80
    v_mfma_f32_16x16x32_bf16 v[236:239], v[228:231], a[64:67], 0
    s_cmp_eq_u32 s36, 3
    s_cselect_b32 s58, s47, s58
    v_mfma_f32_16x16x32_bf16 v[244:247], a[64:67], a[64:67], 0
    s_lshl_b32 s52, s40, 1
    buffer_load_dwordx4 v251, s[4:7], s43 offen offset:3072 lds
    v_mfma_f32_16x16x32_bf16 v[232:235], v[228:231], a[4:7], v[232:235]
    s_and_b32 s53, s36, 1
    v_mfma_f32_16x16x32_bf16 v[240:243], a[4:7], a[4:7], v[240:243]
    s_add_u32 s52, s52, s53
    v_mfma_f32_16x16x32_bf16 v[236:239], v[228:231], a[68:71], v[236:239]
    s_lshl_b32 s48, s52, 5
    v_mfma_f32_16x16x32_bf16 v[244:247], a[68:71], a[68:71], v[244:247]
    s_add_u32 s48, s48, s42
    s_add_u32 m0, s44, 65536
    s_add_u32 s43, s43, 0x80
    s_and_b32 s43, s43, 0x3ff
    buffer_load_dwordx4 v248, s[4:7], s43 offen offset:0 lds
    v_mfma_f32_16x16x32_bf16 v[192:195], a[0:3], a[128:131], 0
    s_lshl_b32 s48, s48, 4
    v_mfma_f32_16x16x32_bf16 v[200:203], a[64:67], a[128:131], 0
    s_add_u32 s48, s48, 0x1420000
    v_mfma_f32_16x16x32_bf16 v[196:199], a[0:3], a[132:135], 0
    s_lshl_b32 s52, s52, 16
    v_mfma_f32_16x16x32_bf16 v[204:207], a[64:67], a[132:135], 0
    s_lshl_b32 s53, s42, 7
    buffer_load_dwordx4 v249, s[4:7], s43 offen offset:1024 lds
    v_mfma_f32_16x16x32_bf16 v[192:195], a[4:7], a[136:139], v[192:195]
    s_add_u32 s52, s52, s53
    v_mfma_f32_16x16x32_bf16 v[200:203], a[68:71], a[136:139], v[200:203]
    s_add_u32 s52, s52, 0x200000
    v_mfma_f32_16x16x32_bf16 v[196:199], a[4:7], a[140:143], v[196:199]
    s_add_u32 s53, s52, 0x8000
    v_mfma_f32_16x16x32_bf16 v[204:207], a[68:71], a[140:143], v[204:207]
    v_and_b32 v224, 3, v2
    buffer_load_dwordx4 v250, s[4:7], s43 offen offset:2048 lds
    s_waitcnt vmcnt(11)
    ds_read_b128 a[16:19], v7 offset:16384
    ds_read_b128 a[80:83], v7 offset:18432
    ds_read_b128 a[20:23], v8 offset:16384
    ds_read_b128 a[84:87], v8 offset:18432
    s_waitcnt lgkmcnt(4)
    v_mfma_f32_16x16x32_bf16 v[232:235], v[228:231], a[8:11], v[232:235]
    v_cmp_eq_u32 s[54:55], 1, v224
    v_mfma_f32_16x16x32_bf16 v[240:243], a[8:11], a[8:11], v[240:243]
    v_cmp_eq_u32 s[56:57], 2, v224
    v_mfma_f32_16x16x32_bf16 v[236:239], v[228:231], a[72:75], v[236:239]
    v_cmp_eq_u32 vcc, 3, v224
    v_mfma_f32_16x16x32_bf16 v[244:247], a[72:75], a[72:75], v[244:247]
    v_lshrrev_b32 v224, 2, v2
    buffer_load_dwordx4 v251, s[4:7], s43 offen offset:3072 lds
    v_mfma_f32_16x16x32_bf16 v[232:235], v[228:231], a[12:15], v[232:235]
    v_lshl_add_u32 v224, v224, 4, v2
    v_mfma_f32_16x16x32_bf16 v[240:243], a[12:15], a[12:15], v[240:243]
    v_lshlrev_b32 v224, 2, v224
    v_mfma_f32_16x16x32_bf16 v[236:239], v[228:231], a[76:79], v[236:239]
    v_mfma_f32_16x16x32_bf16 v[244:247], a[76:79], a[76:79], v[244:247]
    s_add_u32 m0, s44, 131072
    s_add_u32 s43, s43, 0x80
    s_and_b32 s43, s43, 0x3ff
    buffer_load_dwordx4 v248, s[4:7], s43 offen offset:0 lds
    v_mfma_f32_16x16x32_bf16 v[192:195], a[8:11], a[144:147], v[192:195]
    v_mfma_f32_16x16x32_bf16 v[200:203], a[72:75], a[144:147], v[200:203]
    v_mfma_f32_16x16x32_bf16 v[196:199], a[8:11], a[148:151], v[196:199]
    v_mfma_f32_16x16x32_bf16 v[204:207], a[72:75], a[148:151], v[204:207]
    buffer_load_dwordx4 v249, s[4:7], s43 offen offset:1024 lds
    v_mfma_f32_16x16x32_bf16 v[192:195], a[12:15], a[152:155], v[192:195]
    v_mfma_f32_16x16x32_bf16 v[200:203], a[76:79], a[152:155], v[200:203]
    v_mfma_f32_16x16x32_bf16 v[196:199], a[12:15], a[156:159], v[196:199]
    v_mfma_f32_16x16x32_bf16 v[204:207], a[76:79], a[156:159], v[204:207]
    buffer_load_dwordx4 v250, s[4:7], s43 offen offset:2048 lds
    s_waitcnt vmcnt(11)
    ds_read_b128 a[24:27], v7 offset:32768
    ds_read_b128 a[88:91], v7 offset:34816
    ds_read_b128 a[28:31], v8 offset:32768
    ds_read_b128 a[92:95], v8 offset:34816
    s_waitcnt lgkmcnt(4)
    v_mfma_f32_16x16x32_bf16 v[232:235], v[228:231], a[16:19], v[232:235]
    v_mfma_f32_16x16x32_bf16 v[240:243], a[16:19], a[16:19], v[240:243]
    v_mfma_f32_16x16x32_bf16 v[236:239], v[228:231], a[80:83], v[236:239]
    v_mfma_f32_16x16x32_bf16 v[244:247], a[80:83], a[80:83], v[244:247]
    buffer_load_dwordx4 v251, s[4:7], s43 offen offset:3072 lds
    v_mfma_f32_16x16x32_bf16 v[232:235], v[228:231], a[20:23], v[232:235]
    v_mfma_f32_16x16x32_bf16 v[240:243], a[20:23], a[20:23], v[240:243]
    v_mfma_f32_16x16x32_bf16 v[236:239], v[228:231], a[84:87], v[236:239]
    v_mfma_f32_16x16x32_bf16 v[244:247], a[84:87], a[84:87], v[244:247]
    s_add_u32 m0, s44, 147456
    s_add_u32 s43, s43, 0x80
    s_and_b32 s43, s43, 0x3ff
    buffer_load_dwordx4 v248, s[4:7], s43 offen offset:0 lds
    v_mfma_f32_16x16x32_bf16 v[192:195], a[16:19], a[160:163], v[192:195]
    v_mfma_f32_16x16x32_bf16 v[200:203], a[80:83], a[160:163], v[200:203]
    v_mfma_f32_16x16x32_bf16 v[196:199], a[16:19], a[164:167], v[196:199]
    v_mfma_f32_16x16x32_bf16 v[204:207], a[80:83], a[164:167], v[204:207]
    buffer_load_dwordx4 v249, s[4:7], s43 offen offset:1024 lds
    v_mfma_f32_16x16x32_bf16 v[192:195], a[20:23], a[168:171], v[192:195]
    v_mfma_f32_16x16x32_bf16 v[200:203], a[84:87], a[168:171], v[200:203]
    v_mfma_f32_16x16x32_bf16 v[196:199], a[20:23], a[172:175], v[196:199]
    v_mfma_f32_16x16x32_bf16 v[204:207], a[84:87], a[172:175], v[204:207]
    buffer_load_dwordx4 v250, s[4:7], s43 offen offset:2048 lds
    s_waitcnt vmcnt(11)
    ds_read_b128 a[32:35], v7 offset:49152
    ds_read_b128 a[96:99], v7 offset:51200
    ds_read_b128 a[36:39], v8 offset:49152
    ds_read_b128 a[100:103], v8 offset:51200
    s_waitcnt lgkmcnt(4)
    v_mfma_f32_16x16x32_bf16 v[232:235], v[228:231], a[24:27], v[232:235]
    v_mfma_f32_16x16x32_bf16 v[240:243], a[24:27], a[24:27], v[240:243]
    v_mfma_f32_16x16x32_bf16 v[236:239], v[228:231], a[88:91], v[236:239]
    v_mfma_f32_16x16x32_bf16 v[244:247], a[88:91], a[88:91], v[244:247]
    buffer_load_dwordx4 v251, s[4:7], s43 offen offset:3072 lds
    v_mfma_f32_16x16x32_bf16 v[232:235], v[228:231], a[28:31], v[232:235]
    v_mfma_f32_16x16x32_bf16 v[240:243], a[28:31], a[28:31], v[240:243]
    v_mfma_f32_16x16x32_bf16 v[236:239], v[228:231], a[92:95], v[236:239]
    v_mfma_f32_16x16x32_bf16 v[244:247], a[92:95], a[92:95], v[244:247]
    s_add_u32 m0, s46, 0
    s_nop 0
    buffer_load_dwordx4 v252, s[16:19], s61 offen lds
    v_mfma_f32_16x16x32_bf16 v[192:195], a[24:27], a[176:179], v[192:195]
    v_mfma_f32_16x16x32_bf16 v[200:203], a[88:91], a[176:179], v[200:203]
    v_mfma_f32_16x16x32_bf16 v[196:199], a[24:27], a[180:183], v[196:199]
    v_mfma_f32_16x16x32_bf16 v[204:207], a[88:91], a[180:183], v[204:207]
    s_add_u32 s50, m0, s45
    s_min_u32 m0, s50, 0x30000
    s_nop 0
    buffer_load_dwordx4 v253, s[16:19], s61 offen lds
    v_mfma_f32_16x16x32_bf16 v[192:195], a[28:31], a[184:187], v[192:195]
    v_mfma_f32_16x16x32_bf16 v[200:203], a[92:95], a[184:187], v[200:203]
    v_mfma_f32_16x16x32_bf16 v[196:199], a[28:31], a[188:191], v[196:199]
    v_mfma_f32_16x16x32_bf16 v[204:207], a[92:95], a[188:191], v[204:207]
    s_add_u32 m0, s46, 7168
    s_add_u32 s61, s61, 114688
    buffer_load_dwordx4 v252, s[16:19], s61 offen lds
    s_waitcnt vmcnt(11)
    ds_read_b128 a[40:43], v9 offset:0
    ds_read_b128 a[104:107], v9 offset:2048
    ds_read_b128 a[44:47], v10 offset:0
    ds_read_b128 a[108:111], v10 offset:2048
    s_waitcnt lgkmcnt(4)
    v_mfma_f32_16x16x32_bf16 v[232:235], v[228:231], a[32:35], v[232:235]
    v_mfma_f32_16x16x32_bf16 v[240:243], a[32:35], a[32:35], v[240:243]
    v_mfma_f32_16x16x32_bf16 v[236:239], v[228:231], a[96:99], v[236:239]
    v_mfma_f32_16x16x32_bf16 v[244:247], a[96:99], a[96:99], v[244:247]
    s_add_u32 s50, m0, s45
    s_min_u32 m0, s50, 0x30000
    s_nop 0
    buffer_load_dwordx4 v253, s[16:19], s61 offen lds
    v_mfma_f32_16x16x32_bf16 v[232:235], v[228:231], a[36:39], v[232:235]
    v_mfma_f32_16x16x32_bf16 v[240:243], a[36:39], a[36:39], v[240:243]
    v_mfma_f32_16x16x32_bf16 v[236:239], v[228:231], a[100:103], v[236:239]
    v_mfma_f32_16x16x32_bf16 v[244:247], a[100:103], a[100:103], v[244:247]
    s_add_u32 m0, s46, 86016
    s_add_u32 s61, s61, 114688
    s_cmp_eq_u32 s61, 1835008
    s_cselect_b32 s61, 0, s61
    buffer_load_dwordx4 v252, s[16:19], s61 offen lds
    v_mfma_f32_16x16x32_bf16 v[208:211], a[32:35], a[128:131], 0
    v_mfma_f32_16x16x32_bf16 v[216:219], a[96:99], a[128:131], 0
    v_mfma_f32_16x16x32_bf16 v[212:215], a[32:35], a[132:135], 0
    v_mfma_f32_16x16x32_bf16 v[220:223], a[96:99], a[132:135], 0
    s_add_u32 s50, m0, s45
    s_min_u32 m0, s50, 0x30000
    s_nop 0
    buffer_load_dwordx4 v253, s[16:19], s61 offen lds
    v_mfma_f32_16x16x32_bf16 v[208:211], a[36:39], a[136:139], v[208:211]
    v_mfma_f32_16x16x32_bf16 v[216:219], a[100:103], a[136:139], v[216:219]
    v_mfma_f32_16x16x32_bf16 v[212:215], a[36:39], a[140:143], v[212:215]
    v_mfma_f32_16x16x32_bf16 v[220:223], a[100:103], a[140:143], v[220:223]
    s_add_u32 m0, s46, 93184
    s_add_u32 s61, s61, 114688
    buffer_load_dwordx4 v252, s[16:19], s61 offen lds
    s_waitcnt vmcnt(11)
    ds_read_b128 a[48:51], v11 offset:0
    ds_read_b128 a[112:115], v11 offset:2048
    ds_read_b128 a[52:55], v12 offset:0
    ds_read_b128 a[116:119], v12 offset:2048
    s_waitcnt lgkmcnt(4)
    s_barrier
    v_mfma_f32_16x16x32_bf16 v[232:235], v[228:231], a[40:43], v[232:235]
    v_mfma_f32_16x16x32_bf16 v[240:243], a[40:43], a[40:43], v[240:243]
    v_mfma_f32_16x16x32_bf16 v[236:239], v[228:231], a[104:107], v[236:239]
    v_mfma_f32_16x16x32_bf16 v[244:247], a[104:107], a[104:107], v[244:247]
    s_add_u32 s50, m0, s45
    s_min_u32 m0, s50, 0x30000
    s_nop 0
    buffer_load_dwordx4 v253, s[16:19], s61 offen lds
    v_mfma_f32_16x16x32_bf16 v[232:235], v[228:231], a[44:47], v[232:235]
    v_mfma_f32_16x16x32_bf16 v[240:243], a[44:47], a[44:47], v[240:243]
    v_mfma_f32_16x16x32_bf16 v[236:239], v[228:231], a[108:111], v[236:239]
    v_mfma_f32_16x16x32_bf16 v[244:247], a[108:111], a[108:111], v[244:247]
    buffer_load_dwordx4 a[192:195], v14, s[8:11], 0 offen
    buffer_load_dwordx4 a[196:199], v14, s[12:15], 0 offen
    buffer_load_dword a200, v15, s[20:23], 0 offen
    buffer_load_dword v255, v254, s[32:35], 0 offen sc1
    v_mfma_f32_16x16x32_bf16 v[208:211], a[40:43], a[144:147], v[208:211]
    v_mfma_f32_16x16x32_bf16 v[216:219], a[104:107], a[144:147], v[216:219]
    v_mfma_f32_16x16x32_bf16 v[212:215], a[40:43], a[148:151], v[212:215]
    v_mfma_f32_16x16x32_bf16 v[220:223], a[104:107], a[148:151], v[220:223]
    s_add_u32 m0, s46, 100352
    s_add_u32 s61, s61, 114688
    s_cmp_eq_u32 s61, 1835008
    s_cselect_b32 s61, 0, s61
    buffer_load_dwordx4 v252, s[16:19], s61 offen lds
    v_mfma_f32_16x16x32_bf16 v[208:211], a[44:47], a[152:155], v[208:211]
    v_mfma_f32_16x16x32_bf16 v[216:219], a[108:111], a[152:155], v[216:219]
    v_mfma_f32_16x16x32_bf16 v[212:215], a[44:47], a[156:159], v[212:215]
    v_mfma_f32_16x16x32_bf16 v[220:223], a[108:111], a[156:159], v[220:223]
    s_add_u32 s50, m0, s45
    s_min_u32 m0, s50, 0x30000
    s_nop 0
    buffer_load_dwordx4 v253, s[16:19], s61 offen lds
    s_waitcnt vmcnt(14)
    ds_read_b128 a[56:59], v11 offset:16384
    ds_read_b128 a[120:123], v11 offset:18432
    ds_read_b128 a[60:63], v12 offset:16384
    ds_read_b128 a[124:127], v12 offset:18432
    s_waitcnt lgkmcnt(4)
    v_mfma_f32_16x16x32_bf16 v[232:235], v[228:231], a[48:51], v[232:235]
    v_mfma_f32_16x16x32_bf16 v[240:243], a[48:51], a[48:51], v[240:243]
    v_mfma_f32_16x16x32_bf16 v[236:239], v[228:231], a[112:115], v[236:239]
    v_mfma_f32_16x16x32_bf16 v[244:247], a[112:115], a[112:115], v[244:247]
    s_add_u32 m0, s46, 107520
    s_add_u32 s61, s61, 114688
    buffer_load_dwordx4 v252, s[16:19], s61 offen lds
    v_mfma_f32_16x16x32_bf16 v[232:235], v[228:231], a[52:55], v[232:235]
    v_mfma_f32_16x16x32_bf16 v[240:243], a[52:55], a[52:55], v[240:243]
    v_mfma_f32_16x16x32_bf16 v[236:239], v[228:231], a[116:119], v[236:239]
    v_mfma_f32_16x16x32_bf16 v[244:247], a[116:119], a[116:119], v[244:247]
    s_add_u32 s50, m0, s45
    s_min_u32 m0, s50, 0x30000
    s_nop 0
    buffer_load_dwordx4 v253, s[16:19], s61 offen lds
    v_mfma_f32_16x16x32_bf16 v[208:211], a[48:51], a[160:163], v[208:211]
    v_mfma_f32_16x16x32_bf16 v[216:219], a[112:115], a[160:163], v[216:219]
    v_mfma_f32_16x16x32_bf16 v[212:215], a[48:51], a[164:167], v[212:215]
    v_mfma_f32_16x16x32_bf16 v[220:223], a[112:115], a[164:167], v[220:223]
    s_add_u32 m0, s46, 14336
    s_add_u32 s61, s61, 114688
    s_cmp_eq_u32 s61, 1835008
    s_cselect_b32 s61, 0, s61
    buffer_load_dwordx4 v252, s[16:19], s61 offen lds
    v_mfma_f32_16x16x32_bf16 v[208:211], a[52:55], a[168:171], v[208:211]
    v_mfma_f32_16x16x32_bf16 v[216:219], a[116:119], a[168:171], v[216:219]
    v_mfma_f32_16x16x32_bf16 v[212:215], a[52:55], a[172:175], v[212:215]
    v_mfma_f32_16x16x32_bf16 v[220:223], a[116:119], a[172:175], v[220:223]
    s_add_u32 s50, m0, s45
    s_min_u32 m0, s50, 0x30000
    s_nop 0
    buffer_load_dwordx4 v253, s[16:19], s61 offen lds
    s_waitcnt lgkmcnt(0)
    v_mfma_f32_16x16x32_bf16 v[232:235], v[228:231], a[56:59], v[232:235]
    v_mfma_f32_16x16x32_bf16 v[240:243], a[56:59], a[56:59], v[240:243]
    v_mfma_f32_16x16x32_bf16 v[236:239], v[228:231], a[120:123], v[236:239]
    v_mfma_f32_16x16x32_bf16 v[244:247], a[120:123], a[120:123], v[244:247]
    s_add_u32 m0, s46, 21504
    s_add_u32 s61, s61, 114688
    buffer_load_dwordx4 v252, s[16:19], s61 offen lds
    v_mfma_f32_16x16x32_bf16 v[232:235], v[228:231], a[60:63], v[232:235]
    v_mfma_f32_16x16x32_bf16 v[240:243], a[60:63], a[60:63], v[240:243]
    v_mfma_f32_16x16x32_bf16 v[236:239], v[228:231], a[124:127], v[236:239]
    v_mfma_f32_16x16x32_bf16 v[244:247], a[124:127], a[124:127], v[244:247]
    s_add_u32 s50, m0, s45
    s_min_u32 m0, s50, 0x30000
    s_nop 0
    buffer_load_dwordx4 v253, s[16:19], s61 offen lds
    v_mfma_f32_16x16x32_bf16 v[208:211], a[56:59], a[176:179], v[208:211]
    v_mfma_f32_16x16x32_bf16 v[216:219], a[120:123], a[176:179], v[216:219]
    v_mfma_f32_16x16x32_bf16 v[212:215], a[56:59], a[180:183], v[212:215]
    v_mfma_f32_16x16x32_bf16 v[220:223], a[120:123], a[180:183], v[220:223]
    s_add_u32 m0, s46, 28672
    s_add_u32 s61, s61, 114688
    s_cmp_eq_u32 s61, 1835008
    s_cselect_b32 s61, 0, s61
    buffer_load_dwordx4 v252, s[16:19], s61 offen lds
    v_mfma_f32_16x16x32_bf16 v[208:211], a[60:63], a[184:187], v[208:211]
    v_mfma_f32_16x16x32_bf16 v[216:219], a[124:127], a[184:187], v[216:219]
    v_mfma_f32_16x16x32_bf16 v[212:215], a[60:63], a[188:191], v[212:215]
    v_mfma_f32_16x16x32_bf16 v[220:223], a[124:127], a[188:191], v[220:223]
    s_add_u32 s50, m0, s45
    s_min_u32 m0, s50, 0x30000
    s_nop 0
    buffer_load_dwordx4 v253, s[16:19], s61 offen lds
    v_cndmask_b32 v240, v240, v241, s[54:55]
    v_cndmask_b32 v244, v244, v245, s[54:55]
    v_cndmask_b32 v240, v240, v242, s[56:57]
    v_cndmask_b32 v244, v244, v246, s[56:57]
    v_cndmask_b32 v240, v240, v243, vcc
    v_cndmask_b32 v244, v244, v247, vcc
    ds_bpermute_b32 v241, v224, v240
    ds_bpermute_b32 v245, v224, v244
    v_mul_f32 v14, 0x3b000000, v232
    v_mul_f32 v15, 0x3b000000, v236
    s_waitcnt lgkmcnt(0)
    v_mul_f32 v241, 0x3b000000, v241
    v_mul_f32 v245, 0x3b000000, v245
    v_fma_f32 v241, -v14, v14, v241
    v_fma_f32 v245, -v15, v15, v245
    v_max_f32 v241, 0, v241
    v_max_f32 v245, 0, v245
    v_cvt_pk_bf16_f32 v241, v241, v241
    v_cvt_pk_bf16_f32 v245, v245, v245
    v_cvt_pk_bf16_f32 v14, -v14, -v14
    v_cvt_pk_bf16_f32 v15, -v15, -v15
    v_and_b32 v14, 0xffff0000, v14
    v_and_b32 v15, 0xffff0000, v15
    v_lshlrev_b32 v241, 16, v241
    s_add_u32 m0, s46, 35840
    s_add_u32 s61, s61, 114688
    buffer_load_dwordx4 v252, s[16:19], s61 offen lds
    v_lshlrev_b32 v245, 16, v245
    v_add_f32 v241, 0x3727c5ac, v241
    v_add_f32 v245, 0x3727c5ac, v245
    v_cvt_pk_bf16_f32 v241, v241, v241
    v_cvt_pk_bf16_f32 v245, v245, v245
    v_lshlrev_b32 v241, 16, v241
    v_lshlrev_b32 v245, 16, v245
    v_sqrt_f32 v241, v241
    v_sqrt_f32 v245, v245
    v_cvt_pk_bf16_f32 v241, v241, v241
    v_cvt_pk_bf16_f32 v245, v245, v245
    v_lshlrev_b32 v241, 16, v241
    v_lshlrev_b32 v245, 16, v245
    v_rcp_f32 v224, v241
    v_rcp_f32 v226, v245
    v_mov_b32 v238, v241
    v_mov_b32 v239, v241
    v_mov_b32 v246, v245
    v_mov_b32 v247, v245
    s_add_u32 s50, m0, s45
    s_min_u32 m0, s50, 0x30000
    s_nop 0
    buffer_load_dwordx4 v253, s[16:19], s61 offen lds
    v_mul_f32 v236, 0x36000000, v224
    v_mul_f32 v244, 0x36000000, v226
    v_mov_b32 v237, v14
    v_mov_b32 v245, v15
    v_lshlrev_b32 v14, 4, v3
    ds_bpermute_b32 v232, v14, v236 offset:0
    ds_bpermute_b32 v233, v14, v236 offset:4
    ds_bpermute_b32 v234, v14, v236 offset:8
    ds_bpermute_b32 v235, v14, v236 offset:12
    ds_bpermute_b32 v240, v14, v244 offset:0
    ds_bpermute_b32 v241, v14, v244 offset:4
    ds_bpermute_b32 v242, v14, v244 offset:8
    ds_bpermute_b32 v243, v14, v244 offset:12
    v_mul_f32 v224, 0xbfb8aa3b, v224
    v_mul_f32 v226, 0xbfb8aa3b, v226
    v_mov_b32 v225, v224
    v_mov_b32 v227, v226
    v_bfe_u32 v11, v2, 1, 1
    v_cvt_f32_u32 v11, v11
    v_fma_f32 v11, v11, -2.0, 1.0
    s_lshl_b32 s54, s40, 5
    v_add_u32 v12, s54, v2
    v_cmp_gt_u32 vcc, 2, v12
    s_add_u32 m0, s46, 43008
    s_add_u32 s61, s61, 114688
    s_cmp_eq_u32 s61, 1835008
    s_cselect_b32 s61, 0, s61
    buffer_load_dwordx4 v252, s[16:19], s61 offen lds
    v_mov_b32 v12, 1.0
    v_cndmask_b32 v12, v12, 0.5, vcc
    v_and_b32 v8, 14, v2
    v_xor_b32 v8, v8, v3
    v_lshlrev_b32 v8, 3, v8
    v_lshl_add_u32 v15, v2, 7, v8
    s_and_b32 s54, s36, 1
    s_lshl_b32 s54, s54, 6
    s_lshr_b32 s55, s36, 1
    s_lshl_b32 s55, s55, 12
    s_add_u32 s55, s55, 131072
    v_xor_b32 v7, s54, v15
    v_add_u32 v7, s55, v7
    v_xor_b32 v8, 32, v7
    v_fma_f32 v192, v208, v11, v192
    v_fma_f32 v193, v209, v11, v193
    v_fma_f32 v194, v210, v11, v194
    v_fma_f32 v195, v211, v11, v195
    v_fma_f32 v196, v212, v11, v196
    v_fma_f32 v197, v213, v11, v197
    v_fma_f32 v198, v214, v11, v198
    v_fma_f32 v199, v215, v11, v199
    v_fma_f32 v200, v216, v11, v200
    s_add_u32 s50, m0, s45
    s_min_u32 m0, s50, 0x30000
    s_nop 0
    buffer_load_dwordx4 v253, s[16:19], s61 offen lds
    v_fma_f32 v201, v217, v11, v201
    v_fma_f32 v202, v218, v11, v202
    v_fma_f32 v203, v219, v11, v203
    v_fma_f32 v204, v220, v11, v204
    v_fma_f32 v205, v221, v11, v205
    v_fma_f32 v206, v222, v11, v206
    v_fma_f32 v207, v223, v11, v207
    v_mul_f32 v192, v192, v12
    v_mul_f32 v193, v193, v12
    v_mul_f32 v194, v194, v12
    v_mul_f32 v195, v195, v12
    v_mul_f32 v200, v200, v12
    v_mul_f32 v201, v201, v12
    v_mul_f32 v202, v202, v12
    v_mul_f32 v203, v203, v12
    s_waitcnt lgkmcnt(0)
    v_mul_f32 v192, v192, v232
    v_mul_f32 v193, v193, v233
    v_mul_f32 v194, v194, v234
    v_mul_f32 v195, v195, v235
    v_cvt_pk_bf16_f32 v208, v192, v193
    v_cvt_pk_bf16_f32 v209, v194, v195
    ds_write_b64 v7, v[208:209] offset:0
    v_mul_f32 v196, v196, v232
    s_add_u32 m0, s46, 50176
    s_add_u32 s61, s61, 114688
    buffer_load_dwordx4 v252, s[16:19], s61 offen lds
    v_mul_f32 v197, v197, v233
    v_mul_f32 v198, v198, v234
    v_mul_f32 v199, v199, v235
    v_cvt_pk_bf16_f32 v210, v196, v197
    v_cvt_pk_bf16_f32 v211, v198, v199
    ds_write_b64 v7, v[210:211] offset:2048
    v_mul_f32 v200, v200, v240
    v_mul_f32 v201, v201, v241
    v_mul_f32 v202, v202, v242
    v_mul_f32 v203, v203, v243
    v_cvt_pk_bf16_f32 v212, v200, v201
    v_cvt_pk_bf16_f32 v213, v202, v203
    ds_write_b64 v8, v[212:213] offset:0
    v_mul_f32 v204, v204, v240
    v_mul_f32 v205, v205, v241
    v_mul_f32 v206, v206, v242
    v_mul_f32 v207, v207, v243
    v_cvt_pk_bf16_f32 v214, v204, v205
    v_cvt_pk_bf16_f32 v215, v206, v207
    ds_write_b64 v8, v[214:215] offset:2048
    s_lshl_b32 s56, s36, 4
    v_lshrrev_b32 v9, 2, v1
    v_add_u32 v9, s56, v9
    s_add_u32 s50, m0, s45
    s_min_u32 m0, s50, 0x30000
    s_nop 0
    buffer_load_dwordx4 v253, s[16:19], s61 offen lds
    v_and_b32 v10, 3, v1
    v_lshlrev_b32 v11, 3, v10
    v_xor_b32 v9, v9, v11
    v_lshlrev_b32 v9, 2, v9
    v_lshl_add_u32 v9, v10, 11, v9
    v_add_u32 v9, 139264, v9
    s_mov_b32 s56, 0x05040100
    s_mov_b32 s57, 0x07060302
    s_waitcnt vmcnt(16)
    v_accvgpr_read_b32 v200, a192
    v_accvgpr_read_b32 v201, a193
    v_accvgpr_read_b32 v202, a194
    v_accvgpr_read_b32 v203, a195
    v_accvgpr_read_b32 v204, a196
    v_accvgpr_read_b32 v205, a197
    v_accvgpr_read_b32 v206, a198
    v_accvgpr_read_b32 v207, a199
    v_perm_b32 v192, v204, v200, s56
    ds_write_b32 v9, v192 offset:0
    v_perm_b32 v193, v204, v200, s57
    ds_write_b32 v9, v193 offset:256
    v_perm_b32 v194, v205, v201, s56
    ds_write_b32 v9, v194 offset:512
    v_perm_b32 v195, v205, v201, s57
    s_add_u32 m0, s46, 57344
    s_add_u32 s61, s61, 114688
    s_cmp_eq_u32 s61, 1835008
    s_cselect_b32 s61, 0, s61
    buffer_load_dwordx4 v252, s[16:19], s61 offen lds
    ds_write_b32 v9, v195 offset:768
    v_perm_b32 v196, v206, v202, s56
    ds_write_b32 v9, v196 offset:1024
    v_perm_b32 v197, v206, v202, s57
    ds_write_b32 v9, v197 offset:1280
    v_perm_b32 v198, v207, v203, s56
    ds_write_b32 v9, v198 offset:1536
    v_perm_b32 v199, v207, v203, s57
    ds_write_b32 v9, v199 offset:1792
    v_readfirstlane_b32 s3, v255
    s_lshl_b32 s56, s36, 1
    v_xor_b32 v9, s56, v2
    v_lshlrev_b32 v9, 4, v9
    v_lshl_add_u32 v9, v3, 8, v9
    s_lshl_b32 s57, s36, 11
    s_add_u32 s56, s57, 139264
    v_add_u32 v9, s56, v9
    v_lshrrev_b32 v14, 3, v1
    v_lshl_add_u32 v12, v14, 7, v0
    s_bfe_u32 s56, s42, 0x30001
    s_lshl_b32 s56, s56, 4
    s_add_u32 s57, s57, 131072
    v_xor_b32 v7, s56, v12
    s_add_u32 s50, m0, s45
    s_min_u32 m0, s50, 0x30000
    s_nop 0
    buffer_load_dwordx4 v253, s[16:19], s61 offen lds
    v_add_u32 v7, s57, v7
    v_xor_b32 v8, 64, v7
    v_and_b32 v10, 0x70, v4
    v_lshl_add_u32 v14, v14, 12, v10
    s_lshl_b32 s49, s38, 5
    s_lshl_b32 s56, s36, 3
    s_add_u32 s49, s49, s56
    s_add_u32 s49, s49, 1
    v_add_u32 v10, s49, v3
    v_add_u32 v11, 4, v10
    v_and_b32 v10, 255, v10
    v_and_b32 v11, 255, v11
    v_lshlrev_b32 v10, 13, v10
    v_lshlrev_b32 v11, 13, v11
    v_lshl_add_u32 v10, v2, 4, v10
    v_lshl_add_u32 v11, v2, 4, v11
    s_lshl_b32 s49, s37, 8
    s_add_u32 s49, s49, 0x400000
    s_lshl_b32 s54, s38, 2
    s_add_u32 s54, s54, s36
    s_lshl_b32 s54, s54, 5
    s_add_u32 s54, s54, s37
    s_lshl_b32 s54, s54, 4
    s_add_u32 m0, s46, 64512
    s_add_u32 s61, s61, 114688
    buffer_load_dwordx4 v252, s[16:19], s61 offen lds
    s_add_u32 s54, s54, 0x1480000
    s_lshl_b32 s55, s40, 10
    s_add_u32 s55, s55, 0x1400000
    v_add_u32 v248, s47, v5
    v_add_u32 v249, s58, v5
    v_add_u32 v250, s47, v6
    v_add_u32 v251, s58, v6
    s_waitcnt vmcnt(23) lgkmcnt(0)
    s_barrier
    ds_read_b128 v[208:211], v7
    ds_read_b128 v[212:215], v8 offset:1024
    ds_read_b128 v[192:195], v9
    ds_read_b128 v[196:199], v9 offset:1024
    ds_read_b64_tr_b16 v[80:81], v5 offset:0
    ds_read_b64_tr_b16 v[82:83], v5 offset:3584
    ds_read_b64_tr_b16 v[84:85], v5 offset:32
    ds_read_b64_tr_b16 v[86:87], v5 offset:3616
    ds_read_b64_tr_b16 v[88:89], v5 offset:64
    ds_read_b64_tr_b16 v[90:91], v5 offset:3648
    ds_read_b64_tr_b16 v[92:93], v5 offset:96
    ds_read_b64_tr_b16 v[94:95], v5 offset:3680
    ds_read_b64_tr_b16 v[96:97], v5 offset:128
    ds_read_b64_tr_b16 v[98:99], v5 offset:3712
    ds_read_b64_tr_b16 v[100:101], v5 offset:160
    ds_read_b64_tr_b16 v[102:103], v5 offset:3744
    ds_read_b64_tr_b16 v[104:105], v5 offset:192
    ds_read_b64_tr_b16 v[106:107], v5 offset:3776
    ds_read_b64_tr_b16 a[128:129], v248 offset:0
    ds_read_b64_tr_b16 a[130:131], v248 offset:3584
    ds_read_b64_tr_b16 a[132:133], v249 offset:0
    ds_read_b64_tr_b16 a[134:135], v249 offset:3584
    s_waitcnt lgkmcnt(15)
    buffer_store_dwordx4 v[208:211], v14, s[24:27], s52 offen sc1
    buffer_store_dwordx4 v[212:215], v14, s[24:27], s53 offen sc1
    buffer_store_dwordx4 v[192:195], v10, s[24:27], s49 offen sc1
    buffer_store_dwordx4 v[196:199], v11, s[24:27], s49 offen sc1
    s_waitcnt lgkmcnt(12)
    v_mfma_f32_16x16x32_bf16 v[136:139], v[80:83], a[0:3], 0
    ds_read_b64_tr_b16 v[108:109], v5 offset:7168
    v_mfma_f32_16x16x32_bf16 v[164:167], v[80:83], a[64:67], 0
    ds_read_b64_tr_b16 v[110:111], v5 offset:10752
    v_mfma_f32_16x16x32_bf16 v[140:143], v[84:87], a[0:3], 0
    ds_read_b64_tr_b16 v[112:113], v5 offset:7200
    s_add_u32 s50, m0, s45
    s_min_u32 m0, s50, 0x30000
    s_nop 0
    buffer_load_dwordx4 v253, s[16:19], s61 offen lds
    v_mfma_f32_16x16x32_bf16 v[168:171], v[84:87], a[64:67], 0
    ds_read_b64_tr_b16 v[114:115], v5 offset:10784
    v_mfma_f32_16x16x32_bf16 v[144:147], v[88:91], a[0:3], 0
    ds_read_b64_tr_b16 v[116:117], v5 offset:7232
    v_mfma_f32_16x16x32_bf16 v[172:175], v[88:91], a[64:67], 0
    ds_read_b64_tr_b16 v[118:119], v5 offset:10816
    s_waitcnt lgkmcnt(10)
    v_mfma_f32_16x16x32_bf16 v[148:151], v[92:95], a[0:3], 0
    ds_read_b64_tr_b16 v[120:121], v5 offset:7264
    s_add_u32 m0, s46, 71680
    s_add_u32 s61, s61, 114688
    s_cmp_eq_u32 s61, 1835008
    s_cselect_b32 s61, 0, s61
    buffer_load_dwordx4 v252, s[16:19], s61 offen lds
    v_mfma_f32_16x16x32_bf16 v[176:179], v[92:95], a[64:67], 0
    ds_read_b64_tr_b16 v[122:123], v5 offset:10848
    v_mfma_f32_16x16x32_bf16 v[152:155], v[96:99], a[0:3], 0
    ds_read_b64_tr_b16 v[124:125], v5 offset:7296
    v_mfma_f32_16x16x32_bf16 v[180:183], v[96:99], a[64:67], 0
    ds_read_b64_tr_b16 v[126:127], v5 offset:10880
    v_mfma_f32_16x16x32_bf16 v[156:159], v[100:103], a[0:3], 0
    ds_read_b64_tr_b16 v[128:129], v5 offset:7328
    s_add_u32 s50, m0, s45
    s_min_u32 m0, s50, 0x30000
    s_nop 0
    buffer_load_dwordx4 v253, s[16:19], s61 offen lds
    v_mfma_f32_16x16x32_bf16 v[184:187], v[100:103], a[64:67], 0
    ds_read_b64_tr_b16 v[130:131], v5 offset:10912
    v_mfma_f32_16x16x32_bf16 v[160:163], v[104:107], a[0:3], 0
    ds_read_b64_tr_b16 v[132:133], v5 offset:7360
    v_mfma_f32_16x16x32_bf16 v[188:191], v[104:107], a[64:67], 0
    ds_read_b64_tr_b16 v[134:135], v5 offset:10944
    s_waitcnt lgkmcnt(14)
    v_mfma_f32_16x16x32_bf16 a[184:187], a[128:131], v[228:231], 0
    ds_read_b64_tr_b16 a[136:137], v248 offset:7168
    ds_read_b64_tr_b16 a[138:139], v248 offset:10752
    s_add_u32 m0, s46, 78848
    s_add_u32 s61, s61, 114688
    buffer_load_dwordx4 v252, s[16:19], s61 offen lds
    v_mfma_f32_16x16x32_bf16 a[188:191], a[132:135], v[228:231], 0
    ds_read_b64_tr_b16 a[140:141], v249 offset:7168
    ds_read_b64_tr_b16 a[142:143], v249 offset:10752
    s_waitcnt lgkmcnt(12)
    v_mfma_f32_16x16x32_bf16 v[136:139], v[108:111], a[4:7], v[136:139]
    ds_read_b64_tr_b16 v[80:81], v6 offset:28672
    v_mfma_f32_16x16x32_bf16 v[164:167], v[108:111], a[68:71], v[164:167]
    ds_read_b64_tr_b16 v[82:83], v6 offset:32256
    v_mfma_f32_16x16x32_bf16 v[140:143], v[112:115], a[4:7], v[140:143]
    ds_read_b64_tr_b16 v[84:85], v6 offset:28704
    s_add_u32 s50, m0, s45
    s_min_u32 m0, s50, 0x30000
    s_nop 0
    buffer_load_dwordx4 v253, s[16:19], s61 offen lds
    v_mfma_f32_16x16x32_bf16 v[168:171], v[112:115], a[68:71], v[168:171]
    ds_read_b64_tr_b16 v[86:87], v6 offset:32288
    v_mfma_f32_16x16x32_bf16 v[144:147], v[116:119], a[4:7], v[144:147]
    ds_read_b64_tr_b16 v[88:89], v6 offset:28736
    v_mfma_f32_16x16x32_bf16 v[172:175], v[116:119], a[68:71], v[172:175]
    ds_read_b64_tr_b16 v[90:91], v6 offset:32320
    s_waitcnt lgkmcnt(10)
    v_mfma_f32_16x16x32_bf16 v[148:151], v[120:123], a[4:7], v[148:151]
    ds_read_b64_tr_b16 v[92:93], v6 offset:28768
    v_mfma_f32_16x16x32_bf16 v[176:179], v[120:123], a[68:71], v[176:179]
    ds_read_b64_tr_b16 v[94:95], v6 offset:32352
    v_mfma_f32_16x16x32_bf16 v[152:155], v[124:127], a[4:7], v[152:155]
    ds_read_b64_tr_b16 v[96:97], v6 offset:28800
    v_mfma_f32_16x16x32_bf16 v[180:183], v[124:127], a[68:71], v[180:183]
    ds_read_b64_tr_b16 v[98:99], v6 offset:32384
    v_mfma_f32_16x16x32_bf16 v[156:159], v[128:131], a[4:7], v[156:159]
    ds_read_b64_tr_b16 v[100:101], v6 offset:28832
    v_mfma_f32_16x16x32_bf16 v[184:187], v[128:131], a[68:71], v[184:187]
    ds_read_b64_tr_b16 v[102:103], v6 offset:32416
    v_mfma_f32_16x16x32_bf16 v[160:163], v[132:135], a[4:7], v[160:163]
    ds_read_b64_tr_b16 v[104:105], v6 offset:28864
    v_mfma_f32_16x16x32_bf16 v[188:191], v[132:135], a[68:71], v[188:191]
    ds_read_b64_tr_b16 v[106:107], v6 offset:32448
    s_waitcnt lgkmcnt(14)
    v_mfma_f32_16x16x32_bf16 a[184:187], a[136:139], v[228:231], a[184:187]
    ds_read_b64_tr_b16 a[128:129], v250 offset:28672
    ds_read_b64_tr_b16 a[130:131], v250 offset:32256
    v_mfma_f32_16x16x32_bf16 a[188:191], a[140:143], v[228:231], a[188:191]
    ds_read_b64_tr_b16 a[132:133], v251 offset:28672
    ds_read_b64_tr_b16 a[134:135], v251 offset:32256
    s_waitcnt lgkmcnt(12)
    v_mfma_f32_16x16x32_bf16 v[136:139], v[80:83], a[8:11], v[136:139]
    ds_read_b64_tr_b16 v[108:109], v6 offset:35840
    v_mfma_f32_16x16x32_bf16 v[164:167], v[80:83], a[72:75], v[164:167]
    ds_read_b64_tr_b16 v[110:111], v6 offset:39424
    v_mfma_f32_16x16x32_bf16 v[140:143], v[84:87], a[8:11], v[140:143]
    ds_read_b64_tr_b16 v[112:113], v6 offset:35872
    v_mfma_f32_16x16x32_bf16 v[168:171], v[84:87], a[72:75], v[168:171]
    ds_read_b64_tr_b16 v[114:115], v6 offset:39456
    v_mfma_f32_16x16x32_bf16 v[144:147], v[88:91], a[8:11], v[144:147]
    ds_read_b64_tr_b16 v[116:117], v6 offset:35904
    v_mfma_f32_16x16x32_bf16 v[172:175], v[88:91], a[72:75], v[172:175]
    ds_read_b64_tr_b16 v[118:119], v6 offset:39488
    s_waitcnt lgkmcnt(10)
    v_mfma_f32_16x16x32_bf16 v[148:151], v[92:95], a[8:11], v[148:151]
    ds_read_b64_tr_b16 v[120:121], v6 offset:35936
    v_mfma_f32_16x16x32_bf16 v[176:179], v[92:95], a[72:75], v[176:179]
    ds_read_b64_tr_b16 v[122:123], v6 offset:39520
    v_mfma_f32_16x16x32_bf16 v[152:155], v[96:99], a[8:11], v[152:155]
    ds_read_b64_tr_b16 v[124:125], v6 offset:35968
    v_mfma_f32_16x16x32_bf16 v[180:183], v[96:99], a[72:75], v[180:183]
    ds_read_b64_tr_b16 v[126:127], v6 offset:39552
    v_mfma_f32_16x16x32_bf16 v[156:159], v[100:103], a[8:11], v[156:159]
    ds_read_b64_tr_b16 v[128:129], v6 offset:36000
    v_mfma_f32_16x16x32_bf16 v[184:187], v[100:103], a[72:75], v[184:187]
    ds_read_b64_tr_b16 v[130:131], v6 offset:39584
    v_mfma_f32_16x16x32_bf16 v[160:163], v[104:107], a[8:11], v[160:163]
    ds_read_b64_tr_b16 v[132:133], v6 offset:36032
    v_mfma_f32_16x16x32_bf16 v[188:191], v[104:107], a[72:75], v[188:191]
    ds_read_b64_tr_b16 v[134:135], v6 offset:39616
    s_waitcnt lgkmcnt(14)
    v_mfma_f32_16x16x32_bf16 a[184:187], a[128:131], v[228:231], a[184:187]
    ds_read_b64_tr_b16 a[136:137], v250 offset:35840
    ds_read_b64_tr_b16 a[138:139], v250 offset:39424
    v_mfma_f32_16x16x32_bf16 a[188:191], a[132:135], v[228:231], a[188:191]
    ds_read_b64_tr_b16 a[140:141], v251 offset:35840
    ds_read_b64_tr_b16 a[142:143], v251 offset:39424
    s_waitcnt vmcnt(20)
    s_barrier
    s_waitcnt lgkmcnt(12)
    v_mfma_f32_16x16x32_bf16 v[136:139], v[108:111], a[12:15], v[136:139]
    ds_read_b64_tr_b16 v[80:81], v6 offset:43008
    v_mfma_f32_16x16x32_bf16 v[164:167], v[108:111], a[76:79], v[164:167]
    ds_read_b64_tr_b16 v[82:83], v6 offset:46592
    v_mfma_f32_16x16x32_bf16 v[140:143], v[112:115], a[12:15], v[140:143]
    ds_read_b64_tr_b16 v[84:85], v6 offset:43040
    v_mfma_f32_16x16x32_bf16 v[168:171], v[112:115], a[76:79], v[168:171]
    ds_read_b64_tr_b16 v[86:87], v6 offset:46624
    v_mfma_f32_16x16x32_bf16 v[144:147], v[116:119], a[12:15], v[144:147]
    ds_read_b64_tr_b16 v[88:89], v6 offset:43072
    v_mfma_f32_16x16x32_bf16 v[172:175], v[116:119], a[76:79], v[172:175]
    ds_read_b64_tr_b16 v[90:91], v6 offset:46656
    s_waitcnt lgkmcnt(10)
    v_mfma_f32_16x16x32_bf16 v[148:151], v[120:123], a[12:15], v[148:151]
    ds_read_b64_tr_b16 v[92:93], v6 offset:43104
    v_mfma_f32_16x16x32_bf16 v[176:179], v[120:123], a[76:79], v[176:179]
    ds_read_b64_tr_b16 v[94:95], v6 offset:46688
    v_mfma_f32_16x16x32_bf16 v[152:155], v[124:127], a[12:15], v[152:155]
    ds_read_b64_tr_b16 v[96:97], v6 offset:43136
    v_mfma_f32_16x16x32_bf16 v[180:183], v[124:127], a[76:79], v[180:183]
    ds_read_b64_tr_b16 v[98:99], v6 offset:46720
    v_mfma_f32_16x16x32_bf16 v[156:159], v[128:131], a[12:15], v[156:159]
    ds_read_b64_tr_b16 v[100:101], v6 offset:43168
    v_mfma_f32_16x16x32_bf16 v[184:187], v[128:131], a[76:79], v[184:187]
    ds_read_b64_tr_b16 v[102:103], v6 offset:46752
    v_mfma_f32_16x16x32_bf16 v[160:163], v[132:135], a[12:15], v[160:163]
    ds_read_b64_tr_b16 v[104:105], v6 offset:43200
    v_mfma_f32_16x16x32_bf16 v[188:191], v[132:135], a[76:79], v[188:191]
    ds_read_b64_tr_b16 v[106:107], v6 offset:46784
    s_waitcnt lgkmcnt(14)
    v_mfma_f32_16x16x32_bf16 a[184:187], a[136:139], v[228:231], a[184:187]
    ds_read_b64_tr_b16 a[128:129], v250 offset:43008
    ds_read_b64_tr_b16 a[130:131], v250 offset:46592
    v_mfma_f32_16x16x32_bf16 a[188:191], a[140:143], v[228:231], a[188:191]
    ds_read_b64_tr_b16 a[132:133], v251 offset:43008
    ds_read_b64_tr_b16 a[134:135], v251 offset:46592
    s_waitcnt lgkmcnt(12)
    v_mfma_f32_16x16x32_bf16 v[136:139], v[80:83], a[16:19], v[136:139]
    ds_read_b64_tr_b16 v[108:109], v6 offset:50176
    v_mfma_f32_16x16x32_bf16 v[164:167], v[80:83], a[80:83], v[164:167]
    ds_read_b64_tr_b16 v[110:111], v6 offset:53760
    v_mfma_f32_16x16x32_bf16 v[140:143], v[84:87], a[16:19], v[140:143]
    ds_read_b64_tr_b16 v[112:113], v6 offset:50208
    v_mfma_f32_16x16x32_bf16 v[168:171], v[84:87], a[80:83], v[168:171]
    ds_read_b64_tr_b16 v[114:115], v6 offset:53792
    v_mfma_f32_16x16x32_bf16 v[144:147], v[88:91], a[16:19], v[144:147]
    ds_read_b64_tr_b16 v[116:117], v6 offset:50240
    v_mfma_f32_16x16x32_bf16 v[172:175], v[88:91], a[80:83], v[172:175]
    ds_read_b64_tr_b16 v[118:119], v6 offset:53824
    s_waitcnt lgkmcnt(10)
    v_mfma_f32_16x16x32_bf16 v[148:151], v[92:95], a[16:19], v[148:151]
    ds_read_b64_tr_b16 v[120:121], v6 offset:50272
    v_mfma_f32_16x16x32_bf16 v[176:179], v[92:95], a[80:83], v[176:179]
    ds_read_b64_tr_b16 v[122:123], v6 offset:53856
    v_mfma_f32_16x16x32_bf16 v[152:155], v[96:99], a[16:19], v[152:155]
    ds_read_b64_tr_b16 v[124:125], v6 offset:50304
    v_mfma_f32_16x16x32_bf16 v[180:183], v[96:99], a[80:83], v[180:183]
    ds_read_b64_tr_b16 v[126:127], v6 offset:53888
    v_mfma_f32_16x16x32_bf16 v[156:159], v[100:103], a[16:19], v[156:159]
    ds_read_b64_tr_b16 v[128:129], v6 offset:50336
    v_mfma_f32_16x16x32_bf16 v[184:187], v[100:103], a[80:83], v[184:187]
    ds_read_b64_tr_b16 v[130:131], v6 offset:53920
    v_mfma_f32_16x16x32_bf16 v[160:163], v[104:107], a[16:19], v[160:163]
    ds_read_b64_tr_b16 v[132:133], v6 offset:50368
    v_mfma_f32_16x16x32_bf16 v[188:191], v[104:107], a[80:83], v[188:191]
    ds_read_b64_tr_b16 v[134:135], v6 offset:53952
    s_waitcnt lgkmcnt(14)
    v_mfma_f32_16x16x32_bf16 a[184:187], a[128:131], v[228:231], a[184:187]
    ds_read_b64_tr_b16 a[136:137], v250 offset:50176
    ds_read_b64_tr_b16 a[138:139], v250 offset:53760
    v_mfma_f32_16x16x32_bf16 a[188:191], a[132:135], v[228:231], a[188:191]
    ds_read_b64_tr_b16 a[140:141], v251 offset:50176
    ds_read_b64_tr_b16 a[142:143], v251 offset:53760
    s_waitcnt lgkmcnt(12)
    v_mfma_f32_16x16x32_bf16 v[136:139], v[108:111], a[20:23], v[136:139]
    ds_read_b64_tr_b16 v[80:81], v5 offset:14336
    s_lshr_b32 s50, s2, 6
    v_mfma_f32_16x16x32_bf16 v[164:167], v[108:111], a[84:87], v[164:167]
    ds_read_b64_tr_b16 v[82:83], v5 offset:17920
    s_mul_i32 s50, s50, 458752
    v_mfma_f32_16x16x32_bf16 v[140:143], v[112:115], a[20:23], v[140:143]
    ds_read_b64_tr_b16 v[84:85], v5 offset:14368
    s_bfe_u32 s51, s2, 0x30003
    v_mfma_f32_16x16x32_bf16 v[168:171], v[112:115], a[84:87], v[168:171]
    ds_read_b64_tr_b16 v[86:87], v5 offset:17952
    s_mul_i32 s51, s51, 28672
    v_mfma_f32_16x16x32_bf16 v[144:147], v[116:119], a[20:23], v[144:147]
    ds_read_b64_tr_b16 v[88:89], v5 offset:14400
    s_add_u32 s50, s50, s51
    v_mfma_f32_16x16x32_bf16 v[172:175], v[116:119], a[84:87], v[172:175]
    ds_read_b64_tr_b16 v[90:91], v5 offset:17984
    s_mul_i32 s51, s36, 7168
    s_waitcnt lgkmcnt(10)
    v_mfma_f32_16x16x32_bf16 v[148:151], v[120:123], a[20:23], v[148:151]
    ds_read_b64_tr_b16 v[92:93], v5 offset:14432
    s_add_u32 s50, s50, s51
    v_mfma_f32_16x16x32_bf16 v[176:179], v[120:123], a[84:87], v[176:179]
    ds_read_b64_tr_b16 v[94:95], v5 offset:18016
    s_add_u32 s50, s50, 229376
    v_mfma_f32_16x16x32_bf16 v[152:155], v[124:127], a[20:23], v[152:155]
    ds_read_b64_tr_b16 v[96:97], v5 offset:14464
    v_lshlrev_b32 v7, 7, v1
    v_mfma_f32_16x16x32_bf16 v[180:183], v[124:127], a[84:87], v[180:183]
    ds_read_b64_tr_b16 v[98:99], v5 offset:18048
    v_mov_b32 v8, 0x7ff00000
    v_mfma_f32_16x16x32_bf16 v[156:159], v[128:131], a[20:23], v[156:159]
    ds_read_b64_tr_b16 v[100:101], v5 offset:14496
    v_cmp_gt_u32 vcc, 56, v1
    v_mfma_f32_16x16x32_bf16 v[184:187], v[128:131], a[84:87], v[184:187]
    ds_read_b64_tr_b16 v[102:103], v5 offset:18080
    v_cndmask_b32 v7, v8, v7, vcc
    v_mfma_f32_16x16x32_bf16 v[160:163], v[132:135], a[20:23], v[160:163]
    ds_read_b64_tr_b16 v[104:105], v5 offset:14528
    buffer_load_dword a202, v7, s[20:23], s50 offen
    v_mfma_f32_16x16x32_bf16 v[188:191], v[132:135], a[84:87], v[188:191]
    ds_read_b64_tr_b16 v[106:107], v5 offset:18112
    s_waitcnt lgkmcnt(14)
    v_mfma_f32_16x16x32_bf16 a[184:187], a[136:139], v[228:231], a[184:187]
    ds_read_b64_tr_b16 a[128:129], v248 offset:14336
    ds_read_b64_tr_b16 a[130:131], v248 offset:17920
    v_mfma_f32_16x16x32_bf16 a[188:191], a[140:143], v[228:231], a[188:191]
    ds_read_b64_tr_b16 a[132:133], v249 offset:14336
    ds_read_b64_tr_b16 a[134:135], v249 offset:17920
    s_waitcnt lgkmcnt(12)
    v_mfma_f32_16x16x32_bf16 v[136:139], v[80:83], a[24:27], v[136:139]
    ds_read_b64_tr_b16 v[108:109], v5 offset:21504
    v_mfma_f32_16x16x32_bf16 v[164:167], v[80:83], a[88:91], v[164:167]
    ds_read_b64_tr_b16 v[110:111], v5 offset:25088
    v_mfma_f32_16x16x32_bf16 v[140:143], v[84:87], a[24:27], v[140:143]
    ds_read_b64_tr_b16 v[112:113], v5 offset:21536
    v_mfma_f32_16x16x32_bf16 v[168:171], v[84:87], a[88:91], v[168:171]
    ds_read_b64_tr_b16 v[114:115], v5 offset:25120
    v_mfma_f32_16x16x32_bf16 v[144:147], v[88:91], a[24:27], v[144:147]
    ds_read_b64_tr_b16 v[116:117], v5 offset:21568
    v_mfma_f32_16x16x32_bf16 v[172:175], v[88:91], a[88:91], v[172:175]
    ds_read_b64_tr_b16 v[118:119], v5 offset:25152
    s_waitcnt lgkmcnt(10)
    v_mfma_f32_16x16x32_bf16 v[148:151], v[92:95], a[24:27], v[148:151]
    ds_read_b64_tr_b16 v[120:121], v5 offset:21600
    v_mfma_f32_16x16x32_bf16 v[176:179], v[92:95], a[88:91], v[176:179]
    ds_read_b64_tr_b16 v[122:123], v5 offset:25184
    v_mfma_f32_16x16x32_bf16 v[152:155], v[96:99], a[24:27], v[152:155]
    ds_read_b64_tr_b16 v[124:125], v5 offset:21632
    v_mfma_f32_16x16x32_bf16 v[180:183], v[96:99], a[88:91], v[180:183]
    ds_read_b64_tr_b16 v[126:127], v5 offset:25216
    v_mfma_f32_16x16x32_bf16 v[156:159], v[100:103], a[24:27], v[156:159]
    ds_read_b64_tr_b16 v[128:129], v5 offset:21664
    v_mfma_f32_16x16x32_bf16 v[184:187], v[100:103], a[88:91], v[184:187]
    ds_read_b64_tr_b16 v[130:131], v5 offset:25248
    v_mfma_f32_16x16x32_bf16 v[160:163], v[104:107], a[24:27], v[160:163]
    ds_read_b64_tr_b16 v[132:133], v5 offset:21696
    v_mfma_f32_16x16x32_bf16 v[188:191], v[104:107], a[88:91], v[188:191]
    ds_read_b64_tr_b16 v[134:135], v5 offset:25280
    s_waitcnt lgkmcnt(14)
    v_mfma_f32_16x16x32_bf16 a[184:187], a[128:131], v[228:231], a[184:187]
    ds_read_b64_tr_b16 a[136:137], v248 offset:21504
    ds_read_b64_tr_b16 a[138:139], v248 offset:25088
    v_mfma_f32_16x16x32_bf16 a[188:191], a[132:135], v[228:231], a[188:191]
    ds_read_b64_tr_b16 a[140:141], v249 offset:21504
    ds_read_b64_tr_b16 a[142:143], v249 offset:25088
    s_waitcnt vmcnt(1)
    s_barrier
    s_waitcnt lgkmcnt(12)
    v_mfma_f32_16x16x32_bf16 v[136:139], v[108:111], a[28:31], v[136:139]
    ds_read_b64_tr_b16 v[80:81], v5 offset:28672
    v_lshlrev_b32 v253, 5, v3
    v_mfma_f32_16x16x32_bf16 v[164:167], v[108:111], a[92:95], v[164:167]
    ds_read_b64_tr_b16 v[82:83], v5 offset:32256
    v_xor_b32 v252, v253, v4
    v_mfma_f32_16x16x32_bf16 v[140:143], v[112:115], a[28:31], v[140:143]
    ds_read_b64_tr_b16 v[84:85], v5 offset:28704
    v_and_b32 v252, 0x70, v252
    v_mfma_f32_16x16x32_bf16 v[168:171], v[112:115], a[92:95], v[168:171]
    ds_read_b64_tr_b16 v[86:87], v5 offset:32288
    v_lshrrev_b32 v253, 3, v1
    v_mfma_f32_16x16x32_bf16 v[144:147], v[116:119], a[28:31], v[144:147]
    ds_read_b64_tr_b16 v[88:89], v5 offset:28736
    v_lshl_add_u32 v252, v253, 10, v252
    v_mfma_f32_16x16x32_bf16 v[172:175], v[116:119], a[92:95], v[172:175]
    ds_read_b64_tr_b16 v[90:91], v5 offset:32320
    v_add_u32 v253, 7168, v252
    s_waitcnt lgkmcnt(10)
    v_mfma_f32_16x16x32_bf16 v[148:151], v[120:123], a[28:31], v[148:151]
    ds_read_b64_tr_b16 v[92:93], v5 offset:28768
    s_mul_i32 s56, s36, 458752
    v_mfma_f32_16x16x32_bf16 v[176:179], v[120:123], a[92:95], v[176:179]
    ds_read_b64_tr_b16 v[94:95], v5 offset:32352
    s_lshl_b32 s50, s38, 7
    v_mfma_f32_16x16x32_bf16 v[152:155], v[124:127], a[28:31], v[152:155]
    ds_read_b64_tr_b16 v[96:97], v5 offset:28800
    s_add_u32 s56, s56, s50
    v_mfma_f32_16x16x32_bf16 v[180:183], v[124:127], a[92:95], v[180:183]
    ds_read_b64_tr_b16 v[98:99], v5 offset:32384
    s_and_b32 s50, s38, 0
    v_mfma_f32_16x16x32_bf16 v[156:159], v[128:131], a[28:31], v[156:159]
    ds_read_b64_tr_b16 v[100:101], v5 offset:28832
    s_mul_i32 s50, s50, 229376
    v_mfma_f32_16x16x32_bf16 v[184:187], v[128:131], a[92:95], v[184:187]
    ds_read_b64_tr_b16 v[102:103], v5 offset:32416
    s_sub_u32 s57, 229376, s50
    v_mfma_f32_16x16x32_bf16 v[160:163], v[132:135], a[28:31], v[160:163]
    ds_read_b64_tr_b16 v[104:105], v5 offset:28864
    s_add_u32 s57, s57, s56
    v_mfma_f32_16x16x32_bf16 v[188:191], v[132:135], a[92:95], v[188:191]
    ds_read_b64_tr_b16 v[106:107], v5 offset:32448
    s_add_u32 s56, s56, s50
    s_waitcnt lgkmcnt(14)
    v_mfma_f32_16x16x32_bf16 a[184:187], a[136:139], v[228:231], a[184:187]
    ds_read_b64_tr_b16 a[128:129], v248 offset:28672
    ds_read_b64_tr_b16 a[130:131], v248 offset:32256
    v_mfma_f32_16x16x32_bf16 a[188:191], a[140:143], v[228:231], a[188:191]
    ds_read_b64_tr_b16 a[132:133], v249 offset:28672
    ds_read_b64_tr_b16 a[134:135], v249 offset:32256
    s_waitcnt vmcnt(6)
    s_cmp_lg_u32 s3, 0
    s_cbranch_scc1 L_tok_ok
    s_mov_b32 s63, 100000
L_tok:
    buffer_load_dword v255, v254, s[32:35], 0 offen sc1
    s_waitcnt vmcnt(0)
    v_readfirstlane_b32 s3, v255
    s_sub_u32 s63, s63, 1
    s_cselect_b32 s62, 1, s3
    s_cmp_eq_u32 s62, 0
    s_cbranch_scc1 L_tok
L_tok_ok:
    s_mov_b64 exec, 1
    buffer_store_dword v255, v254, s[24:27], s48 offen sc1
    buffer_store_dword v255, v254, s[24:27], s54 offen sc1
    s_mov_b64 exec, -1
    s_waitcnt lgkmcnt(12)
    v_mfma_f32_16x16x32_bf16 v[136:139], v[80:83], a[32:35], v[136:139]
    ds_read_b64_tr_b16 v[108:109], v5 offset:35840
    s_mul_i32 s58, s36, 20480
    v_mfma_f32_16x16x32_bf16 v[164:167], v[80:83], a[96:99], v[164:167]
    ds_read_b64_tr_b16 v[110:111], v5 offset:39424
    s_add_u32 s58, s58, 81920
    v_mfma_f32_16x16x32_bf16 v[140:143], v[84:87], a[32:35], v[140:143]
    ds_read_b64_tr_b16 v[112:113], v5 offset:35872
    s_and_b32 s53, s36, 1
    v_mfma_f32_16x16x32_bf16 v[168:171], v[84:87], a[96:99], v[168:171]
    ds_read_b64_tr_b16 v[114:115], v5 offset:39456
    s_lshl_b32 s53, s53, 13
    v_mfma_f32_16x16x32_bf16 v[144:147], v[88:91], a[32:35], v[144:147]
    ds_read_b64_tr_b16 v[116:117], v5 offset:35904
    s_lshr_b32 s50, s36, 1
    v_mfma_f32_16x16x32_bf16 v[172:175], v[88:91], a[96:99], v[172:175]
    ds_read_b64_tr_b16 v[118:119], v5 offset:39488
    s_lshl_b32 s50, s50, 15
    s_waitcnt lgkmcnt(10)
    v_mfma_f32_16x16x32_bf16 v[148:151], v[92:95], a[32:35], v[148:151]
    ds_read_b64_tr_b16 v[120:121], v5 offset:35936
    s_add_u32 s53, s53, s50
    v_mfma_f32_16x16x32_bf16 v[176:179], v[92:95], a[96:99], v[176:179]
    ds_read_b64_tr_b16 v[122:123], v5 offset:39520
    s_add_u32 s53, s53, 114688
    v_mfma_f32_16x16x32_bf16 v[152:155], v[96:99], a[32:35], v[152:155]
    ds_read_b64_tr_b16 v[124:125], v5 offset:35968
    s_lshl_b32 s55, s36, 14
    v_mfma_f32_16x16x32_bf16 v[180:183], v[96:99], a[96:99], v[180:183]
    ds_read_b64_tr_b16 v[126:127], v5 offset:39552
    s_cmp_eq_u32 s36, 3
    s_cselect_b32 s55, 86016, s55
    v_mfma_f32_16x16x32_bf16 v[156:159], v[100:103], a[32:35], v[156:159]
    ds_read_b64_tr_b16 v[128:129], v5 offset:36000
    s_lshl_b32 s49, s36, 12
    v_mfma_f32_16x16x32_bf16 v[184:187], v[100:103], a[96:99], v[184:187]
    ds_read_b64_tr_b16 v[130:131], v5 offset:39584
    s_add_u32 s49, s49, 131072
    v_mfma_f32_16x16x32_bf16 v[160:163], v[104:107], a[32:35], v[160:163]
    ds_read_b64_tr_b16 v[132:133], v5 offset:36032
    v_add_u32 v194, 73728, v13
    v_mfma_f32_16x16x32_bf16 v[188:191], v[104:107], a[96:99], v[188:191]
    ds_read_b64_tr_b16 v[134:135], v5 offset:39616
    v_xor_b32 v195, 64, v194
    s_waitcnt lgkmcnt(14)
    v_mfma_f32_16x16x32_bf16 a[184:187], a[128:131], v[228:231], a[184:187]
    ds_read_b64_tr_b16 a[136:137], v248 offset:35840
    ds_read_b64_tr_b16 a[138:139], v248 offset:39424
    s_add_u32 m0, s53, 0
    s_add_u32 s59, s56, 0
    buffer_load_dwordx4 v252, s[20:23], s59 offen offset:0 lds
    v_mfma_f32_16x16x32_bf16 a[188:191], a[132:135], v[228:231], a[188:191]
    ds_read_b64_tr_b16 a[140:141], v249 offset:35840
    ds_read_b64_tr_b16 a[142:143], v249 offset:39424
    s_waitcnt lgkmcnt(12)
    v_mfma_f32_16x16x32_bf16 v[136:139], v[108:111], a[36:39], v[136:139]
    ds_read_b64_tr_b16 v[80:81], v5 offset:43008
    v_lshrrev_b32 v7, 1, v2
    v_mfma_f32_16x16x32_bf16 v[164:167], v[108:111], a[100:103], v[164:167]
    ds_read_b64_tr_b16 v[82:83], v5 offset:46592
    v_xor_b32 v7, v7, v3
    v_mfma_f32_16x16x32_bf16 v[140:143], v[112:115], a[36:39], v[140:143]
    ds_read_b64_tr_b16 v[84:85], v5 offset:43040
    v_lshlrev_b32 v7, 3, v7
    buffer_load_dwordx4 v253, s[20:23], s59 offen offset:1024 lds
    v_mfma_f32_16x16x32_bf16 v[168:171], v[112:115], a[100:103], v[168:171]
    ds_read_b64_tr_b16 v[86:87], v5 offset:46624
    v_lshl_add_u32 v7, v2, 6, v7
    v_mfma_f32_16x16x32_bf16 v[144:147], v[116:119], a[36:39], v[144:147]
    ds_read_b64_tr_b16 v[88:89], v5 offset:43072
    s_lshl_b32 s50, s36, 10
    v_mfma_f32_16x16x32_bf16 v[172:175], v[116:119], a[100:103], v[172:175]
    ds_read_b64_tr_b16 v[90:91], v5 offset:46656
    s_add_u32 s50, s50, 65536
    s_waitcnt lgkmcnt(10)
    v_mfma_f32_16x16x32_bf16 v[148:151], v[120:123], a[36:39], v[148:151]
    ds_read_b64_tr_b16 v[92:93], v5 offset:43104
    v_add_u32 v196, s50, v7
    s_add_u32 s59, s56, 14336
    buffer_load_dwordx4 v252, s[20:23], s59 offen offset:2048 lds
    v_mfma_f32_16x16x32_bf16 v[176:179], v[120:123], a[100:103], v[176:179]
    ds_read_b64_tr_b16 v[94:95], v5 offset:46688
    v_xor_b32 v197, 32, v196
    v_mfma_f32_16x16x32_bf16 v[152:155], v[124:127], a[36:39], v[152:155]
    ds_read_b64_tr_b16 v[96:97], v5 offset:43136
    v_bfe_u32 v8, v1, 2, 2
    v_mfma_f32_16x16x32_bf16 v[180:183], v[124:127], a[100:103], v[180:183]
    ds_read_b64_tr_b16 v[98:99], v5 offset:46720
    v_lshl_add_u32 v8, v3, 3, v8
    v_mfma_f32_16x16x32_bf16 v[156:159], v[128:131], a[36:39], v[156:159]
    ds_read_b64_tr_b16 v[100:101], v5 offset:43168
    v_lshlrev_b32 v8, 6, v8
    buffer_load_dwordx4 v253, s[20:23], s59 offen offset:3072 lds
    v_mfma_f32_16x16x32_bf16 v[184:187], v[128:131], a[100:103], v[184:187]
    ds_read_b64_tr_b16 v[102:103], v5 offset:46752
    v_and_b32 v7, 3, v1
    v_mfma_f32_16x16x32_bf16 v[160:163], v[132:135], a[36:39], v[160:163]
    ds_read_b64_tr_b16 v[104:105], v5 offset:43200
    v_bfe_u32 v10, v1, 3, 1
    v_mfma_f32_16x16x32_bf16 v[188:191], v[132:135], a[100:103], v[188:191]
    ds_read_b64_tr_b16 v[106:107], v5 offset:46784
    v_xor_b32 v7, v7, v10
    s_waitcnt lgkmcnt(14)
    v_mfma_f32_16x16x32_bf16 a[184:187], a[136:139], v[228:231], a[184:187]
    ds_read_b64_tr_b16 a[128:129], v248 offset:43008
    ds_read_b64_tr_b16 a[130:131], v248 offset:46592
    s_add_u32 m0, s53, 4096
    s_add_u32 s59, s56, 32768
    buffer_load_dwordx4 v252, s[20:23], s59 offen offset:0 lds
    v_mfma_f32_16x16x32_bf16 a[188:191], a[140:143], v[228:231], a[188:191]
    ds_read_b64_tr_b16 a[132:133], v249 offset:43008
    ds_read_b64_tr_b16 a[134:135], v249 offset:46592
    s_waitcnt lgkmcnt(12)
    v_mfma_f32_16x16x32_bf16 v[136:139], v[80:83], a[40:43], v[136:139]
    ds_read_b64_tr_b16 v[108:109], v5 offset:50176
    v_bfe_u32 v10, v1, 4, 1
    v_mfma_f32_16x16x32_bf16 v[164:167], v[80:83], a[104:107], v[164:167]
    ds_read_b64_tr_b16 v[110:111], v5 offset:53760
    v_lshl_add_u32 v7, v10, 2, v7
    v_mfma_f32_16x16x32_bf16 v[140:143], v[84:87], a[40:43], v[140:143]
    ds_read_b64_tr_b16 v[112:113], v5 offset:50208
    v_lshl_add_u32 v8, v7, 3, v8
    buffer_load_dwordx4 v253, s[20:23], s59 offen offset:1024 lds
    v_mfma_f32_16x16x32_bf16 v[168:171], v[84:87], a[104:107], v[168:171]
    ds_read_b64_tr_b16 v[114:115], v5 offset:53792
    v_add_u32 v198, 65536, v8
    v_mfma_f32_16x16x32_bf16 v[144:147], v[88:91], a[40:43], v[144:147]
    ds_read_b64_tr_b16 v[116:117], v5 offset:50240
    v_xor_b32 v199, 16, v198
    v_mfma_f32_16x16x32_bf16 v[172:175], v[88:91], a[104:107], v[172:175]
    ds_read_b64_tr_b16 v[118:119], v5 offset:53824
    v_xor_b32 v200, 32, v198
    s_waitcnt lgkmcnt(10)
    v_mfma_f32_16x16x32_bf16 v[148:151], v[92:95], a[40:43], v[148:151]
    ds_read_b64_tr_b16 v[120:121], v5 offset:50272
    v_xor_b32 v201, 48, v198
    s_add_u32 s59, s56, 47104
    buffer_load_dwordx4 v252, s[20:23], s59 offen offset:2048 lds
    v_mfma_f32_16x16x32_bf16 v[176:179], v[92:95], a[104:107], v[176:179]
    ds_read_b64_tr_b16 v[122:123], v5 offset:53856
    s_lshl_b32 s50, s36, 5
    v_mfma_f32_16x16x32_bf16 v[152:155], v[96:99], a[40:43], v[152:155]
    ds_read_b64_tr_b16 v[124:125], v5 offset:50304
    v_xor_b32 v7, s50, v15
    v_mfma_f32_16x16x32_bf16 v[180:183], v[96:99], a[104:107], v[180:183]
    ds_read_b64_tr_b16 v[126:127], v5 offset:53888
    v_add_u32 v202, 73728, v7
    v_mfma_f32_16x16x32_bf16 v[156:159], v[100:103], a[40:43], v[156:159]
    ds_read_b64_tr_b16 v[128:129], v5 offset:50336
    s_and_b32 s50, s2, 1
    buffer_load_dwordx4 v253, s[20:23], s59 offen offset:3072 lds
    v_mfma_f32_16x16x32_bf16 v[184:187], v[100:103], a[104:107], v[184:187]
    ds_read_b64_tr_b16 v[130:131], v5 offset:53920
    s_bfe_u32 s51, s2, 0x10002
    v_mfma_f32_16x16x32_bf16 v[160:163], v[104:107], a[40:43], v[160:163]
    ds_read_b64_tr_b16 v[132:133], v5 offset:50368
    s_lshl_b32 s51, s51, 1
    v_mfma_f32_16x16x32_bf16 v[188:191], v[104:107], a[104:107], v[188:191]
    ds_read_b64_tr_b16 v[134:135], v5 offset:53952
    s_or_b32 s50, s50, s51
    s_waitcnt lgkmcnt(14)
    v_mfma_f32_16x16x32_bf16 a[184:187], a[128:131], v[228:231], a[184:187]
    ds_read_b64_tr_b16 a[136:137], v248 offset:50176
    ds_read_b64_tr_b16 a[138:139], v248 offset:53760
    v_mfma_f32_16x16x32_bf16 a[188:191], a[132:135], v[228:231], a[188:191]
    ds_read_b64_tr_b16 a[140:141], v249 offset:50176
    ds_read_b64_tr_b16 a[142:143], v249 offset:53760
    s_barrier
    s_waitcnt lgkmcnt(12)
    v_mfma_f32_16x16x32_bf16 v[136:139], v[108:111], a[44:47], v[136:139]
    ds_read_b64_tr_b16 v[80:81], v6 offset:0
    s_lshl_b32 s50, s50, 5
    v_mfma_f32_16x16x32_bf16 v[164:167], v[108:111], a[108:111], v[164:167]
    ds_read_b64_tr_b16 v[82:83], v6 offset:3584
    v_xor_b32 v7, s50, v12
    v_mfma_f32_16x16x32_bf16 v[140:143], v[112:115], a[44:47], v[140:143]
    ds_read_b64_tr_b16 v[84:85], v6 offset:32
    s_lshl_b32 s43, s36, 11
    s_add_u32 m0, s55, 0
    s_add_u32 s59, s56, 65536
    buffer_load_dwordx4 v252, s[20:23], s59 offen offset:0 lds
    v_mfma_f32_16x16x32_bf16 v[168:171], v[112:115], a[108:111], v[168:171]
    ds_read_b64_tr_b16 v[86:87], v6 offset:3616
    s_add_u32 s51, s43, 73728
    v_mfma_f32_16x16x32_bf16 v[144:147], v[116:119], a[44:47], v[144:147]
    ds_read_b64_tr_b16 v[88:89], v6 offset:64
    v_add_u32 v203, s51, v7
    v_mfma_f32_16x16x32_bf16 v[172:175], v[116:119], a[108:111], v[172:175]
    ds_read_b64_tr_b16 v[90:91], v6 offset:3648
    v_xor_b32 v204, 64, v203
    s_waitcnt lgkmcnt(10)
    v_mfma_f32_16x16x32_bf16 v[148:151], v[120:123], a[44:47], v[148:151]
    ds_read_b64_tr_b16 v[92:93], v6 offset:96
    s_lshl_b32 s50, s2, 13
    buffer_load_dwordx4 v253, s[20:23], s59 offen offset:1024 lds
    v_mfma_f32_16x16x32_bf16 v[176:179], v[120:123], a[108:111], v[176:179]
    ds_read_b64_tr_b16 v[94:95], v6 offset:3680
    s_add_u32 s46, s43, s50
    v_mfma_f32_16x16x32_bf16 v[152:155], v[124:127], a[44:47], v[152:155]
    ds_read_b64_tr_b16 v[96:97], v6 offset:128
    s_add_u32 s45, s46, 0x200000
    v_mfma_f32_16x16x32_bf16 v[180:183], v[124:127], a[108:111], v[180:183]
    ds_read_b64_tr_b16 v[98:99], v6 offset:3712
    s_add_u32 s46, s46, 0x600000
    v_mfma_f32_16x16x32_bf16 v[156:159], v[128:131], a[44:47], v[156:159]
    ds_read_b64_tr_b16 v[100:101], v6 offset:160
    s_add_u32 s43, s43, 73728
    s_add_u32 s59, s56, 79872
    buffer_load_dwordx4 v252, s[20:23], s59 offen offset:2048 lds
    v_mfma_f32_16x16x32_bf16 v[184:187], v[128:131], a[108:111], v[184:187]
    ds_read_b64_tr_b16 v[102:103], v6 offset:3744
    s_lshl_b32 s60, s36, 8
    v_mfma_f32_16x16x32_bf16 v[160:163], v[132:135], a[44:47], v[160:163]
    ds_read_b64_tr_b16 v[104:105], v6 offset:192
    s_add_u32 s60, s60, s50
    v_mfma_f32_16x16x32_bf16 v[188:191], v[132:135], a[108:111], v[188:191]
    ds_read_b64_tr_b16 v[106:107], v6 offset:3776
    s_add_u32 s60, s60, 0x400000
    s_waitcnt lgkmcnt(14)
    v_mfma_f32_16x16x32_bf16 a[184:187], a[136:139], v[228:231], a[184:187]
    ds_read_b64_tr_b16 a[128:129], v250 offset:0
    ds_read_b64_tr_b16 a[130:131], v250 offset:3584
    buffer_load_dwordx4 v253, s[20:23], s59 offen offset:3072 lds
    v_mfma_f32_16x16x32_bf16 a[188:191], a[140:143], v[228:231], a[188:191]
    ds_read_b64_tr_b16 a[132:133], v251 offset:0
    ds_read_b64_tr_b16 a[134:135], v251 offset:3584
    s_waitcnt lgkmcnt(12)
    v_mfma_f32_16x16x32_bf16 v[136:139], v[80:83], a[48:51], v[136:139]
    ds_read_b64_tr_b16 v[108:109], v6 offset:7168
    s_add_u32 s61, s60, 0x1000
    v_mfma_f32_16x16x32_bf16 v[164:167], v[80:83], a[112:115], v[164:167]
    ds_read_b64_tr_b16 v[110:111], v6 offset:10752
    v_lshlrev_b32 v205, 4, v2
    v_mfma_f32_16x16x32_bf16 v[140:143], v[84:87], a[48:51], v[140:143]
    ds_read_b64_tr_b16 v[112:113], v6 offset:7200
    v_lshl_add_u32 v205, v3, 10, v205
    s_add_u32 m0, s55, 4096
    s_add_u32 s59, s56, 114688
    buffer_load_dwordx4 v252, s[20:23], s59 offen offset:0 lds
    v_mfma_f32_16x16x32_bf16 v[168:171], v[84:87], a[112:115], v[168:171]
    ds_read_b64_tr_b16 v[114:115], v6 offset:10784
    s_lshr_b32 s50, s2, 3
    v_mfma_f32_16x16x32_bf16 v[144:147], v[88:91], a[48:51], v[144:147]
    ds_read_b64_tr_b16 v[116:117], v6 offset:7232
    s_lshl_b32 s50, s50, 9
    v_mfma_f32_16x16x32_bf16 v[172:175], v[88:91], a[112:115], v[172:175]
    ds_read_b64_tr_b16 v[118:119], v6 offset:10816
    s_sub_u32 s51, s2, 1
    s_waitcnt lgkmcnt(10)
    v_mfma_f32_16x16x32_bf16 v[148:151], v[92:95], a[48:51], v[148:151]
    ds_read_b64_tr_b16 v[120:121], v6 offset:7264
    s_bfe_u32 s51, s51, 0x50003
    buffer_load_dwordx4 v253, s[20:23], s59 offen offset:1024 lds
    v_mfma_f32_16x16x32_bf16 v[176:179], v[92:95], a[112:115], v[176:179]
    ds_read_b64_tr_b16 v[122:123], v6 offset:10848
    s_lshl_b32 s51, s51, 9
    v_mfma_f32_16x16x32_bf16 v[152:155], v[96:99], a[48:51], v[152:155]
    ds_read_b64_tr_b16 v[124:125], v6 offset:7296
    s_add_u32 s51, s51, 0x5fe00
    v_mfma_f32_16x16x32_bf16 v[180:183], v[96:99], a[112:115], v[180:183]
    ds_read_b64_tr_b16 v[126:127], v6 offset:10880
    v_mov_b32 v7, s50
    v_mfma_f32_16x16x32_bf16 v[156:159], v[100:103], a[48:51], v[156:159]
    ds_read_b64_tr_b16 v[128:129], v6 offset:7328
    v_mov_b32 v8, s51
    s_add_u32 s59, s56, 129024
    buffer_load_dwordx4 v252, s[20:23], s59 offen offset:2048 lds
    v_mfma_f32_16x16x32_bf16 v[184:187], v[100:103], a[112:115], v[184:187]
    ds_read_b64_tr_b16 v[130:131], v6 offset:10912
    v_cmp_gt_u32 vcc, 32, v1
    v_mfma_f32_16x16x32_bf16 v[160:163], v[104:107], a[48:51], v[160:163]
    ds_read_b64_tr_b16 v[132:133], v6 offset:7360
    v_cndmask_b32 v7, v8, v7, vcc
    v_mfma_f32_16x16x32_bf16 v[188:191], v[104:107], a[112:115], v[188:191]
    ds_read_b64_tr_b16 v[134:135], v6 offset:10944
    v_add_u32 v206, v7, v4
    s_waitcnt lgkmcnt(14)
    v_mfma_f32_16x16x32_bf16 a[184:187], a[128:131], v[228:231], a[184:187]
    ds_read_b64_tr_b16 a[136:137], v250 offset:7168
    ds_read_b64_tr_b16 a[138:139], v250 offset:10752
    buffer_load_dwordx4 v253, s[20:23], s59 offen offset:3072 lds
    v_mfma_f32_16x16x32_bf16 a[188:191], a[132:135], v[228:231], a[188:191]
    ds_read_b64_tr_b16 a[140:141], v251 offset:7168
    ds_read_b64_tr_b16 a[142:143], v251 offset:10752
    s_waitcnt lgkmcnt(12)
    v_mfma_f32_16x16x32_bf16 v[136:139], v[108:111], a[52:55], v[136:139]
    ds_read_b64_tr_b16 v[80:81], v6 offset:14336
    s_mul_i32 s44, s42, 56
    v_mfma_f32_16x16x32_bf16 v[164:167], v[108:111], a[116:119], v[164:167]
    ds_read_b64_tr_b16 v[82:83], v6 offset:17920
    s_lshr_b32 s50, s40, 1
    v_mfma_f32_16x16x32_bf16 v[140:143], v[112:115], a[52:55], v[140:143]
    ds_read_b64_tr_b16 v[84:85], v6 offset:14368
    s_mul_i32 s50, s50, 7
    s_add_u32 m0, s55, 8192
    s_add_u32 s59, s56, 147456
    buffer_load_dwordx4 v252, s[20:23], s59 offen offset:0 lds
    v_mfma_f32_16x16x32_bf16 v[168:171], v[112:115], a[116:119], v[168:171]
    ds_read_b64_tr_b16 v[86:87], v6 offset:17952
    s_add_u32 s44, s44, s50
    v_mfma_f32_16x16x32_bf16 v[144:147], v[116:119], a[52:55], v[144:147]
    ds_read_b64_tr_b16 v[88:89], v6 offset:14400
    s_lshl_b32 s44, s44, 12
    v_mfma_f32_16x16x32_bf16 v[172:175], v[116:119], a[116:119], v[172:175]
    ds_read_b64_tr_b16 v[90:91], v6 offset:17984
    s_and_b32 s50, s36, 1
    s_waitcnt lgkmcnt(10)
    v_mfma_f32_16x16x32_bf16 v[148:151], v[120:123], a[52:55], v[148:151]
    ds_read_b64_tr_b16 v[92:93], v6 offset:14432
    s_lshl_b32 s51, s50, 10
    buffer_load_dwordx4 v253, s[20:23], s59 offen offset:1024 lds
    v_mfma_f32_16x16x32_bf16 v[176:179], v[120:123], a[116:119], v[176:179]
    ds_read_b64_tr_b16 v[94:95], v6 offset:18016
    s_add_u32 s44, s44, s51
    v_mfma_f32_16x16x32_bf16 v[152:155], v[124:127], a[52:55], v[152:155]
    ds_read_b64_tr_b16 v[96:97], v6 offset:14464
    s_add_u32 s44, s44, 0xa00000
    v_mfma_f32_16x16x32_bf16 v[180:183], v[124:127], a[116:119], v[180:183]
    ds_read_b64_tr_b16 v[98:99], v6 offset:18048
    s_lshl_b32 s52, s42, 4
    v_mfma_f32_16x16x32_bf16 v[156:159], v[128:131], a[52:55], v[156:159]
    ds_read_b64_tr_b16 v[100:101], v6 offset:14496
    s_add_u32 s52, s52, s40
    s_add_u32 s59, s56, 161792
    buffer_load_dwordx4 v252, s[20:23], s59 offen offset:2048 lds
    v_mfma_f32_16x16x32_bf16 v[184:187], v[128:131], a[116:119], v[184:187]
    ds_read_b64_tr_b16 v[102:103], v6 offset:18080
    s_lshl_b32 s52, s52, 1
    v_mfma_f32_16x16x32_bf16 v[160:163], v[132:135], a[52:55], v[160:163]
    ds_read_b64_tr_b16 v[104:105], v6 offset:14528
    s_add_u32 s52, s52, s50
    v_mfma_f32_16x16x32_bf16 v[188:191], v[132:135], a[116:119], v[188:191]
    ds_read_b64_tr_b16 v[106:107], v6 offset:18112
    s_lshl_b32 s52, s52, 4
    s_waitcnt lgkmcnt(14)
    v_mfma_f32_16x16x32_bf16 a[184:187], a[136:139], v[228:231], a[184:187]
    ds_read_b64_tr_b16 a[128:129], v250 offset:14336
    ds_read_b64_tr_b16 a[130:131], v250 offset:17920
    buffer_load_dwordx4 v253, s[20:23], s59 offen offset:3072 lds
    v_mfma_f32_16x16x32_bf16 a[188:191], a[140:143], v[228:231], a[188:191]
    ds_read_b64_tr_b16 a[132:133], v251 offset:14336
    ds_read_b64_tr_b16 a[134:135], v251 offset:17920
    s_waitcnt lgkmcnt(12)
    v_mfma_f32_16x16x32_bf16 v[136:139], v[80:83], a[56:59], v[136:139]
    ds_read_b64_tr_b16 v[108:109], v6 offset:21504
    s_add_u32 s52, s52, 0x1440000
    v_mfma_f32_16x16x32_bf16 v[164:167], v[80:83], a[120:123], v[164:167]
    ds_read_b64_tr_b16 v[110:111], v6 offset:25088
    s_and_b32 s50, s40, 1
    v_mfma_f32_16x16x32_bf16 v[140:143], v[84:87], a[56:59], v[140:143]
    ds_read_b64_tr_b16 v[112:113], v6 offset:21536
    s_lshl_b32 s47, s50, 11
    s_add_u32 m0, s55, 12288
    s_add_u32 s59, s56, 180224
    buffer_load_dwordx4 v252, s[20:23], s59 offen offset:0 lds
    v_mfma_f32_16x16x32_bf16 v[168:171], v[84:87], a[120:123], v[168:171]
    ds_read_b64_tr_b16 v[114:115], v6 offset:25120
    s_add_u32 s47, s47, s44
    v_mfma_f32_16x16x32_bf16 v[144:147], v[88:91], a[56:59], v[144:147]
    ds_read_b64_tr_b16 v[116:117], v6 offset:21568
    s_add_u32 s47, s47, 24576
    v_mfma_f32_16x16x32_bf16 v[172:175], v[88:91], a[120:123], v[172:175]
    ds_read_b64_tr_b16 v[118:119], v6 offset:25152
    s_mul_i32 s50, s50, 12288
    s_waitcnt lgkmcnt(10)
    v_mfma_f32_16x16x32_bf16 v[148:151], v[92:95], a[56:59], v[148:151]
    ds_read_b64_tr_b16 v[120:121], v6 offset:21600
    s_add_u32 s44, s44, s51
    buffer_load_dwordx4 v253, s[20:23], s59 offen offset:1024 lds
    v_mfma_f32_16x16x32_bf16 v[176:179], v[92:95], a[120:123], v[176:179]
    ds_read_b64_tr_b16 v[122:123], v6 offset:25184
    s_add_u32 s44, s44, s50
    v_mfma_f32_16x16x32_bf16 v[152:155], v[96:99], a[56:59], v[152:155]
    ds_read_b64_tr_b16 v[124:125], v6 offset:21632
    s_mov_b32 s41, 0x1420000
    v_mfma_f32_16x16x32_bf16 v[180:183], v[96:99], a[120:123], v[180:183]
    ds_read_b64_tr_b16 v[126:127], v6 offset:25216
    v_mfma_f32_16x16x32_bf16 v[156:159], v[100:103], a[56:59], v[156:159]
    ds_read_b64_tr_b16 v[128:129], v6 offset:21664
    s_add_u32 s59, s56, 194560
    buffer_load_dwordx4 v252, s[20:23], s59 offen offset:2048 lds
    v_mfma_f32_16x16x32_bf16 v[184:187], v[100:103], a[120:123], v[184:187]
    ds_read_b64_tr_b16 v[130:131], v6 offset:25248
    v_mfma_f32_16x16x32_bf16 v[160:163], v[104:107], a[56:59], v[160:163]
    ds_read_b64_tr_b16 v[132:133], v6 offset:21696
    v_mfma_f32_16x16x32_bf16 v[188:191], v[104:107], a[120:123], v[188:191]
    ds_read_b64_tr_b16 v[134:135], v6 offset:25280
    s_waitcnt lgkmcnt(14)
    v_mfma_f32_16x16x32_bf16 a[184:187], a[128:131], v[228:231], a[184:187]
    ds_read_b64_tr_b16 a[136:137], v250 offset:21504
    ds_read_b64_tr_b16 a[138:139], v250 offset:25088
    buffer_load_dwordx4 v253, s[20:23], s59 offen offset:3072 lds
    v_mfma_f32_16x16x32_bf16 a[188:191], a[132:135], v[228:231], a[188:191]
    ds_read_b64_tr_b16 a[140:141], v251 offset:21504
    ds_read_b64_tr_b16 a[142:143], v251 offset:25088
    s_waitcnt lgkmcnt(12)
    v_mfma_f32_16x16x32_bf16 v[136:139], v[108:111], a[60:63], v[136:139]
    v_mfma_f32_16x16x32_bf16 v[164:167], v[108:111], a[124:127], v[164:167]
    v_mfma_f32_16x16x32_bf16 v[140:143], v[112:115], a[60:63], v[140:143]
    s_add_u32 m0, s49, 0
    s_add_u32 s59, s56, 98304
    buffer_load_dwordx4 v252, s[20:23], s59 offen offset:0 lds
    v_mfma_f32_16x16x32_bf16 v[168:171], v[112:115], a[124:127], v[168:171]
    v_mfma_f32_16x16x32_bf16 v[144:147], v[116:119], a[60:63], v[144:147]
    v_mfma_f32_16x16x32_bf16 v[172:175], v[116:119], a[124:127], v[172:175]
    s_waitcnt lgkmcnt(4)
    v_mfma_f32_16x16x32_bf16 v[148:151], v[120:123], a[60:63], v[148:151]
    buffer_load_dwordx4 v253, s[20:23], s59 offen offset:1024 lds
    v_mfma_f32_16x16x32_bf16 v[176:179], v[120:123], a[124:127], v[176:179]
    v_mfma_f32_16x16x32_bf16 v[152:155], v[124:127], a[60:63], v[152:155]
    v_mfma_f32_16x16x32_bf16 v[180:183], v[124:127], a[124:127], v[180:183]
    v_mfma_f32_16x16x32_bf16 v[156:159], v[128:131], a[60:63], v[156:159]
    s_add_u32 s59, s56, 210944
    buffer_load_dwordx4 v252, s[20:23], s59 offen offset:2048 lds
    v_mfma_f32_16x16x32_bf16 v[184:187], v[128:131], a[124:127], v[184:187]
    v_mfma_f32_16x16x32_bf16 v[160:163], v[132:135], a[60:63], v[160:163]
    v_mfma_f32_16x16x32_bf16 v[188:191], v[132:135], a[124:127], v[188:191]
    s_waitcnt lgkmcnt(0)
    v_mfma_f32_16x16x32_bf16 a[184:187], a[136:139], v[228:231], a[184:187]
    buffer_load_dwordx4 v253, s[20:23], s59 offen offset:3072 lds
    v_mfma_f32_16x16x32_bf16 a[188:191], a[140:143], v[228:231], a[188:191]
    buffer_load_dword v9, v206, s[24:27], s41 offen sc1
    s_lshl_b32 s50, s36, 6
    s_add_u32 s51, s50, 0x100
    s_cmp_eq_u32 s36, 3
    s_cselect_b32 s51, s50, s51
    v_lshlrev_b32 v7, 4, v3
    v_add_u32 v7, 102400, v7
    v_add_u32 v8, s50, v7
    v_add_u32 v10, s51, v7
    s_mov_b32 exec_lo, 0x10001
    s_mov_b32 exec_hi, 0x10001
    ds_write_b128 v8, a[184:187]
    ds_write_b128 v10, a[188:191]
    s_mov_b64 exec, -1
    v_mov_b32 v236, v237
    v_mov_b32 v244, v245
    v_bfe_u32 v249, v1, 3, 2
    v_lshlrev_b32 v249, 5, v249
    v_and_b32 v248, 3, v1
    v_lshl_add_u32 v249, v248, 3, v249
    v_lshrrev_b32 v248, 2, v1
    v_lshl_add_u32 v5, v248, 7, v249
    v_add_u32 v248, s53, v5
    v_xor_b32 v249, 32, v248
    v_xor_b32 v250, 64, v248
    v_xor_b32 v251, 0x60, v248
    s_waitcnt vmcnt(21)
    ds_read_b64_tr_b16 a[144:145], v248 offset:0
    ds_read_b64_tr_b16 a[146:147], v248 offset:2048
    ds_read_b64_tr_b16 a[148:149], v249 offset:0
    ds_read_b64_tr_b16 a[150:151], v249 offset:2048
    ds_read_b64_tr_b16 a[152:153], v250 offset:0
    ds_read_b64_tr_b16 a[154:155], v250 offset:2048
    ds_read_b64_tr_b16 a[156:157], v251 offset:0
    ds_read_b64_tr_b16 a[158:159], v251 offset:2048
    ds_read_b64_tr_b16 a[160:161], v248 offset:4096
    ds_read_b64_tr_b16 a[162:163], v248 offset:6144
    ds_read_b64_tr_b16 a[164:165], v249 offset:4096
    ds_read_b64_tr_b16 a[166:167], v249 offset:6144
    ds_read_b64_tr_b16 a[168:169], v250 offset:4096
    ds_read_b64_tr_b16 a[170:171], v250 offset:6144
    ds_read_b64_tr_b16 a[172:173], v251 offset:4096
    ds_read_b64_tr_b16 a[174:175], v251 offset:6144
    s_waitcnt lgkmcnt(15)
    s_barrier
    ds_read_b128 v[104:107], v7 offset:384
    ds_read_b128 v[80:83], v7 offset:0
    ds_read_b128 v[84:87], v7 offset:64
    ds_read_b128 v[88:91], v7 offset:128
    ds_read_b128 v[92:95], v7 offset:192
    ds_read_b128 v[96:99], v7 offset:256
    ds_read_b128 v[100:103], v7 offset:320
    s_waitcnt lgkmcnt(6)
    v_pk_fma_f32 v[160:161], v[104:105], v[236:237], v[160:161]
    v_pk_fma_f32 v[162:163], v[106:107], v[236:237], v[162:163]
    v_pk_mul_f32 v[112:113], v[160:161], v[224:225]
    v_pk_mul_f32 v[114:115], v[162:163], v[224:225]
    v_exp_f32 v112, v112
    v_exp_f32 v113, v113
    v_exp_f32 v114, v114
    v_exp_f32 v115, v115
    v_pk_fma_f32 v[112:113], v[112:113], v[238:239], v[238:239]
    v_pk_fma_f32 v[114:115], v[114:115], v[238:239], v[238:239]
    v_rcp_f32 v112, v112
    v_rcp_f32 v113, v113
    v_rcp_f32 v114, v114
    v_rcp_f32 v115, v115
    v_pk_mul_f32 v[112:113], v[112:113], v[160:161]
    v_add_u32 v248, s55, v5
    v_xor_b32 v249, 32, v248
    v_xor_b32 v250, 64, v248
    v_xor_b32 v251, 0x60, v248
    s_waitcnt vmcnt(17)
    ds_read_b64_tr_b16 a[176:177], v248 offset:0
    ds_read_b64_tr_b16 a[178:179], v248 offset:2048
    ds_read_b64_tr_b16 a[180:181], v249 offset:0
    ds_read_b64_tr_b16 a[182:183], v249 offset:2048
    ds_read_b64_tr_b16 a[184:185], v250 offset:0
    ds_read_b64_tr_b16 a[186:187], v250 offset:2048
    ds_read_b64_tr_b16 a[188:189], v251 offset:0
    ds_read_b64_tr_b16 a[190:191], v251 offset:2048
    v_pk_mul_f32 v[114:115], v[114:115], v[162:163]
    v_cvt_pk_bf16_f32 v132, v112, v113
    v_cvt_pk_bf16_f32 v133, v114, v115
    v_pk_fma_f32 v[188:189], v[104:105], v[244:245], v[188:189]
    v_pk_fma_f32 v[190:191], v[106:107], v[244:245], v[190:191]
    v_pk_mul_f32 v[116:117], v[188:189], v[226:227]
    v_pk_mul_f32 v[118:119], v[190:191], v[226:227]
    v_exp_f32 v116, v116
    v_exp_f32 v117, v117
    v_exp_f32 v118, v118
    v_exp_f32 v119, v119
    v_pk_fma_f32 v[116:117], v[116:117], v[246:247], v[246:247]
    v_pk_fma_f32 v[118:119], v[118:119], v[246:247], v[246:247]
    v_rcp_f32 v116, v116
    v_rcp_f32 v117, v117
    v_rcp_f32 v118, v118
    s_waitcnt vmcnt(13)
    ds_read_b64_tr_b16 a[192:193], v248 offset:4096
    ds_read_b64_tr_b16 a[194:195], v248 offset:6144
    ds_read_b64_tr_b16 a[196:197], v249 offset:4096
    ds_read_b64_tr_b16 a[198:199], v249 offset:6144
    ds_read_b64_tr_b16 a[200:201], v250 offset:4096
    ds_read_b64_tr_b16 a[202:203], v250 offset:6144
    ds_read_b64_tr_b16 a[204:205], v251 offset:4096
    ds_read_b64_tr_b16 a[206:207], v251 offset:6144
    v_rcp_f32 v119, v119
    v_pk_mul_f32 v[116:117], v[116:117], v[188:189]
    v_pk_mul_f32 v[118:119], v[118:119], v[190:191]
    v_cvt_pk_bf16_f32 v134, v116, v117
    v_cvt_pk_bf16_f32 v135, v118, v119
    s_waitcnt vmcnt(0)
    v_cmp_ne_u32 vcc, s3, v9
    s_cbranch_vccz L_pok_yf
    s_mov_b32 s63, 20000
L_poll_yf:
    s_sleep 16
    buffer_load_dword v9, v206, s[24:27], s41 offen sc1
    s_waitcnt vmcnt(0)
    v_cmp_ne_u32 vcc, s3, v9
    s_sub_u32 s63, s63, 1
    s_cselect_b64 vcc, 0, vcc
    s_nop 4
    s_cbranch_vccnz L_poll_yf
L_pok_yf:
    s_mov_b32 m0, s43
    s_nop 0
    buffer_load_dwordx4 v4, s[24:27], s45 offen sc1 lds
    buffer_load_dwordx4 v4, s[24:27], s45 offen offset:1024 sc1 lds
    buffer_load_dwordx4 v[208:211], v205, s[24:27], s60 offen sc1
    buffer_load_dwordx4 v[212:215], v205, s[24:27], s61 offen sc1
    buffer_store_dwordx4 v[132:135], v4, s[24:27], s47 offen sc1
    s_waitcnt lgkmcnt(15)
    v_pk_fma_f32 v[136:137], v[80:81], v[236:237], v[136:137]
    v_pk_fma_f32 v[138:139], v[82:83], v[236:237], v[138:139]
    v_pk_mul_f32 v[120:121], v[136:137], v[224:225]
    v_pk_mul_f32 v[122:123], v[138:139], v[224:225]
    v_exp_f32 v120, v120
    v_exp_f32 v121, v121
    v_exp_f32 v122, v122
    v_exp_f32 v123, v123
    v_pk_fma_f32 v[120:121], v[120:121], v[238:239], v[238:239]
    v_pk_fma_f32 v[122:123], v[122:123], v[238:239], v[238:239]
    v_rcp_f32 v120, v120
    v_rcp_f32 v121, v121
    s_waitcnt vmcnt(14)
    ds_read_b64_tr_b16 a[208:209], v248 offset:8192
    ds_read_b64_tr_b16 a[210:211], v248 offset:10240
    ds_read_b64_tr_b16 a[212:213], v249 offset:8192
    ds_read_b64_tr_b16 a[214:215], v249 offset:10240
    ds_read_b64_tr_b16 a[216:217], v250 offset:8192
    ds_read_b64_tr_b16 a[218:219], v250 offset:10240
    ds_read_b64_tr_b16 a[220:221], v251 offset:8192
    ds_read_b64_tr_b16 a[222:223], v251 offset:10240
    v_rcp_f32 v122, v122
    v_rcp_f32 v123, v123
    v_pk_mul_f32 v[120:121], v[120:121], v[136:137]
    v_pk_mul_f32 v[122:123], v[122:123], v[138:139]
    v_cvt_pk_bf16_f32 v136, v120, v121
    v_cvt_pk_bf16_f32 v137, v122, v123
    v_pk_fma_f32 v[164:165], v[80:81], v[244:245], v[164:165]
    v_pk_fma_f32 v[166:167], v[82:83], v[244:245], v[166:167]
    v_pk_mul_f32 v[124:125], v[164:165], v[226:227]
    v_pk_mul_f32 v[126:127], v[166:167], v[226:227]
    v_exp_f32 v124, v124
    v_exp_f32 v125, v125
    v_exp_f32 v126, v126
    v_exp_f32 v127, v127
    v_pk_fma_f32 v[124:125], v[124:125], v[246:247], v[246:247]
    v_pk_fma_f32 v[126:127], v[126:127], v[246:247], v[246:247]
    v_rcp_f32 v124, v124
    s_waitcnt vmcnt(10)
    ds_read_b64_tr_b16 a[224:225], v248 offset:12288
    ds_read_b64_tr_b16 a[226:227], v248 offset:14336
    ds_read_b64_tr_b16 a[228:229], v249 offset:12288
    ds_read_b64_tr_b16 a[230:231], v249 offset:14336
    ds_read_b64_tr_b16 a[232:233], v250 offset:12288
    ds_read_b64_tr_b16 a[234:235], v250 offset:14336
    ds_read_b64_tr_b16 a[236:237], v251 offset:12288
    ds_read_b64_tr_b16 a[238:239], v251 offset:14336
    v_rcp_f32 v125, v125
    v_rcp_f32 v126, v126
    v_rcp_f32 v127, v127
    v_pk_mul_f32 v[124:125], v[124:125], v[164:165]
    v_pk_mul_f32 v[126:127], v[126:127], v[166:167]
    v_cvt_pk_bf16_f32 v164, v124, v125
    v_cvt_pk_bf16_f32 v165, v126, v127
    s_waitcnt lgkmcnt(15)
    v_pk_fma_f32 v[140:141], v[84:85], v[236:237], v[140:141]
    v_pk_fma_f32 v[142:143], v[86:87], v[236:237], v[142:143]
    v_pk_mul_f32 v[112:113], v[140:141], v[224:225]
    v_pk_mul_f32 v[114:115], v[142:143], v[224:225]
    v_exp_f32 v112, v112
    v_exp_f32 v113, v113
    v_exp_f32 v114, v114
    v_exp_f32 v115, v115
    v_pk_fma_f32 v[112:113], v[112:113], v[238:239], v[238:239]
    v_add_u32 v248, s49, v5
    v_xor_b32 v249, 32, v248
    v_xor_b32 v250, 64, v248
    v_xor_b32 v251, 0x60, v248
    s_waitcnt vmcnt(6)
    ds_read_b64_tr_b16 a[240:241], v248 offset:0
    ds_read_b64_tr_b16 a[242:243], v248 offset:2048
    ds_read_b64_tr_b16 a[244:245], v249 offset:0
    ds_read_b64_tr_b16 a[246:247], v249 offset:2048
    ds_read_b64_tr_b16 a[248:249], v250 offset:0
    ds_read_b64_tr_b16 a[250:251], v250 offset:2048
    ds_read_b64_tr_b16 a[252:253], v251 offset:0
    ds_read_b64_tr_b16 a[254:255], v251 offset:2048
    v_pk_fma_f32 v[114:115], v[114:115], v[238:239], v[238:239]
    v_rcp_f32 v112, v112
    v_rcp_f32 v113, v113
    v_rcp_f32 v114, v114
    v_rcp_f32 v115, v115
    v_pk_mul_f32 v[112:113], v[112:113], v[140:141]
    v_pk_mul_f32 v[114:115], v[114:115], v[142:143]
    v_cvt_pk_bf16_f32 v138, v112, v113
    v_cvt_pk_bf16_f32 v139, v114, v115
    buffer_store_dwordx4 v[136:139], v4, s[24:27], s44 offen offset:0 sc1
    v_pk_fma_f32 v[168:169], v[84:85], v[244:245], v[168:169]
    v_pk_fma_f32 v[170:171], v[86:87], v[244:245], v[170:171]
    v_pk_mul_f32 v[116:117], v[168:169], v[226:227]
    v_pk_mul_f32 v[118:119], v[170:171], v[226:227]
    v_exp_f32 v116, v116
    v_exp_f32 v117, v117
    v_exp_f32 v118, v118
    v_exp_f32 v119, v119
    v_pk_fma_f32 v[116:117], v[116:117], v[246:247], v[246:247]
    v_pk_fma_f32 v[118:119], v[118:119], v[246:247], v[246:247]
    v_rcp_f32 v116, v116
    v_rcp_f32 v117, v117
    v_rcp_f32 v118, v118
    v_rcp_f32 v119, v119
    v_pk_mul_f32 v[116:117], v[116:117], v[168:169]
    v_pk_mul_f32 v[118:119], v[118:119], v[170:171]
    v_cvt_pk_bf16_f32 v166, v116, v117
    v_cvt_pk_bf16_f32 v167, v118, v119
    buffer_store_dwordx4 v[164:167], v4, s[24:27], s44 offen offset:1024 sc1
    s_add_u32 s44, s44, 0x1000
    s_waitcnt lgkmcnt(15)
    v_pk_fma_f32 v[144:145], v[88:89], v[236:237], v[144:145]
    v_pk_fma_f32 v[146:147], v[90:91], v[236:237], v[146:147]
    v_pk_mul_f32 v[120:121], v[144:145], v[224:225]
    v_pk_mul_f32 v[122:123], v[146:147], v[224:225]
    v_exp_f32 v120, v120
    v_exp_f32 v121, v121
    v_exp_f32 v122, v122
    v_exp_f32 v123, v123
    v_pk_fma_f32 v[120:121], v[120:121], v[238:239], v[238:239]
    v_pk_fma_f32 v[122:123], v[122:123], v[238:239], v[238:239]
    v_rcp_f32 v120, v120
    v_rcp_f32 v121, v121
    v_rcp_f32 v122, v122
    v_rcp_f32 v123, v123
    v_pk_mul_f32 v[120:121], v[120:121], v[144:145]
    v_pk_mul_f32 v[122:123], v[122:123], v[146:147]
    v_cvt_pk_bf16_f32 v144, v120, v121
    v_cvt_pk_bf16_f32 v145, v122, v123
    v_pk_fma_f32 v[172:173], v[88:89], v[244:245], v[172:173]
    v_pk_fma_f32 v[174:175], v[90:91], v[244:245], v[174:175]
    v_pk_mul_f32 v[124:125], v[172:173], v[226:227]
    v_pk_mul_f32 v[126:127], v[174:175], v[226:227]
    v_exp_f32 v124, v124
    v_exp_f32 v125, v125
    v_exp_f32 v126, v126
    v_exp_f32 v127, v127
    v_pk_fma_f32 v[124:125], v[124:125], v[246:247], v[246:247]
    v_pk_fma_f32 v[126:127], v[126:127], v[246:247], v[246:247]
    v_rcp_f32 v124, v124
    v_rcp_f32 v125, v125
    v_rcp_f32 v126, v126
    v_rcp_f32 v127, v127
    v_pk_mul_f32 v[124:125], v[124:125], v[172:173]
    v_pk_mul_f32 v[126:127], v[126:127], v[174:175]
    v_cvt_pk_bf16_f32 v172, v124, v125
    v_cvt_pk_bf16_f32 v173, v126, v127
    s_waitcnt lgkmcnt(15)
    v_pk_fma_f32 v[148:149], v[92:93], v[236:237], v[148:149]
    v_pk_fma_f32 v[150:151], v[94:95], v[236:237], v[150:151]
    v_pk_mul_f32 v[112:113], v[148:149], v[224:225]
    v_pk_mul_f32 v[114:115], v[150:151], v[224:225]
    v_exp_f32 v112, v112
    v_exp_f32 v113, v113
    v_exp_f32 v114, v114
    v_exp_f32 v115, v115
    v_pk_fma_f32 v[112:113], v[112:113], v[238:239], v[238:239]
    v_pk_fma_f32 v[114:115], v[114:115], v[238:239], v[238:239]
    v_rcp_f32 v112, v112
    v_rcp_f32 v113, v113
    v_rcp_f32 v114, v114
    v_rcp_f32 v115, v115
    v_pk_mul_f32 v[112:113], v[112:113], v[148:149]
    v_pk_mul_f32 v[114:115], v[114:115], v[150:151]
    v_cvt_pk_bf16_f32 v146, v112, v113
    v_cvt_pk_bf16_f32 v147, v114, v115
    buffer_store_dwordx4 v[144:147], v4, s[24:27], s44 offen offset:0 sc1
    v_pk_fma_f32 v[176:177], v[92:93], v[244:245], v[176:177]
    v_pk_fma_f32 v[178:179], v[94:95], v[244:245], v[178:179]
    v_pk_mul_f32 v[116:117], v[176:177], v[226:227]
    v_pk_mul_f32 v[118:119], v[178:179], v[226:227]
    v_exp_f32 v116, v116
    v_exp_f32 v117, v117
    v_exp_f32 v118, v118
    v_exp_f32 v119, v119
    v_pk_fma_f32 v[116:117], v[116:117], v[246:247], v[246:247]
    v_pk_fma_f32 v[118:119], v[118:119], v[246:247], v[246:247]
    v_rcp_f32 v116, v116
    v_rcp_f32 v117, v117
    v_rcp_f32 v118, v118
    v_rcp_f32 v119, v119
    v_pk_mul_f32 v[116:117], v[116:117], v[176:177]
    v_pk_mul_f32 v[118:119], v[118:119], v[178:179]
    v_cvt_pk_bf16_f32 v174, v116, v117
    v_cvt_pk_bf16_f32 v175, v118, v119
    buffer_store_dwordx4 v[172:175], v4, s[24:27], s44 offen offset:1024 sc1
    s_add_u32 s44, s44, 0x1000
    s_waitcnt lgkmcnt(15)
    v_pk_fma_f32 v[152:153], v[96:97], v[236:237], v[152:153]
    v_pk_fma_f32 v[154:155], v[98:99], v[236:237], v[154:155]
    v_pk_mul_f32 v[120:121], v[152:153], v[224:225]
    v_pk_mul_f32 v[122:123], v[154:155], v[224:225]
    v_exp_f32 v120, v120
    v_exp_f32 v121, v121
    v_exp_f32 v122, v122
    v_exp_f32 v123, v123
    v_pk_fma_f32 v[120:121], v[120:121], v[238:239], v[238:239]
    v_pk_fma_f32 v[122:123], v[122:123], v[238:239], v[238:239]
    v_rcp_f32 v120, v120
    v_rcp_f32 v121, v121
    v_rcp_f32 v122, v122
    v_rcp_f32 v123, v123
    v_pk_mul_f32 v[120:121], v[120:121], v[152:153]
    v_pk_mul_f32 v[122:123], v[122:123], v[154:155]
    v_cvt_pk_bf16_f32 v152, v120, v121
    v_cvt_pk_bf16_f32 v153, v122, v123
    v_pk_fma_f32 v[180:181], v[96:97], v[244:245], v[180:181]
    v_pk_fma_f32 v[182:183], v[98:99], v[244:245], v[182:183]
    v_pk_mul_f32 v[124:125], v[180:181], v[226:227]
    v_pk_mul_f32 v[126:127], v[182:183], v[226:227]
    v_exp_f32 v124, v124
    v_exp_f32 v125, v125
    v_exp_f32 v126, v126
    v_exp_f32 v127, v127
    v_pk_fma_f32 v[124:125], v[124:125], v[246:247], v[246:247]
    v_pk_fma_f32 v[126:127], v[126:127], v[246:247], v[246:247]
    v_rcp_f32 v124, v124
    v_rcp_f32 v125, v125
    v_rcp_f32 v126, v126
    v_rcp_f32 v127, v127
    v_pk_mul_f32 v[124:125], v[124:125], v[180:181]
    v_pk_mul_f32 v[126:127], v[126:127], v[182:183]
    v_cvt_pk_bf16_f32 v180, v124, v125
    v_cvt_pk_bf16_f32 v181, v126, v127
    s_waitcnt lgkmcnt(15)
    v_pk_fma_f32 v[156:157], v[100:101], v[236:237], v[156:157]
    v_pk_fma_f32 v[158:159], v[102:103], v[236:237], v[158:159]
    v_pk_mul_f32 v[112:113], v[156:157], v[224:225]
    v_pk_mul_f32 v[114:115], v[158:159], v[224:225]
    v_exp_f32 v112, v112
    v_exp_f32 v113, v113
    v_exp_f32 v114, v114
    v_exp_f32 v115, v115
    v_pk_fma_f32 v[112:113], v[112:113], v[238:239], v[238:239]
    v_pk_fma_f32 v[114:115], v[114:115], v[238:239], v[238:239]
    v_rcp_f32 v112, v112
    v_rcp_f32 v113, v113
    v_rcp_f32 v114, v114
    v_rcp_f32 v115, v115
    v_pk_mul_f32 v[112:113], v[112:113], v[156:157]
    v_pk_mul_f32 v[114:115], v[114:115], v[158:159]
    v_cvt_pk_bf16_f32 v154, v112, v113
    v_cvt_pk_bf16_f32 v155, v114, v115
    buffer_store_dwordx4 v[152:155], v4, s[24:27], s44 offen offset:0 sc1
    v_pk_fma_f32 v[184:185], v[100:101], v[244:245], v[184:185]
    v_pk_fma_f32 v[186:187], v[102:103], v[244:245], v[186:187]
    v_pk_mul_f32 v[116:117], v[184:185], v[226:227]
    v_pk_mul_f32 v[118:119], v[186:187], v[226:227]
    v_exp_f32 v116, v116
    v_exp_f32 v117, v117
    v_exp_f32 v118, v118
    v_exp_f32 v119, v119
    v_pk_fma_f32 v[116:117], v[116:117], v[246:247], v[246:247]
    v_pk_fma_f32 v[118:119], v[118:119], v[246:247], v[246:247]
    v_rcp_f32 v116, v116
    v_rcp_f32 v117, v117
    v_rcp_f32 v118, v118
    v_rcp_f32 v119, v119
    v_pk_mul_f32 v[116:117], v[116:117], v[184:185]
    v_pk_mul_f32 v[118:119], v[118:119], v[186:187]
    v_cvt_pk_bf16_f32 v182, v116, v117
    v_cvt_pk_bf16_f32 v183, v118, v119
    buffer_store_dwordx4 v[180:183], v4, s[24:27], s44 offen offset:1024 sc1
    s_waitcnt lgkmcnt(0)
    s_waitcnt vmcnt(7)
    s_barrier
    v_add_u32 v248, s58, v5
    v_xor_b32 v249, 32, v248
    v_xor_b32 v250, 64, v248
    v_xor_b32 v251, 0x60, v248
    ds_read_b128 v[136:139], v194 offset:0
    ds_read_b128 v[144:147], v194 offset:2048
    ds_read_b128 v[152:155], v194 offset:4096
    ds_read_b128 v[160:163], v194 offset:6144
    ds_read_b128 v[140:143], v195 offset:0
    ds_read_b128 v[148:151], v195 offset:2048
    ds_read_b128 v[156:159], v195 offset:4096
    ds_read_b128 v[164:167], v195 offset:6144
    v_lshlrev_b32 v216, 16, v208
    v_and_b32 v128, 0xffff0000, v208
    v_lshlrev_b32 v217, 16, v209
    v_and_b32 v129, 0xffff0000, v209
    v_lshlrev_b32 v218, 16, v210
    v_and_b32 v130, 0xffff0000, v210
    v_lshlrev_b32 v219, 16, v211
    v_and_b32 v131, 0xffff0000, v211
    v_lshlrev_b32 v220, 16, v212
    v_and_b32 v132, 0xffff0000, v212
    v_lshlrev_b32 v221, 16, v213
    v_and_b32 v133, 0xffff0000, v213
    v_lshlrev_b32 v222, 16, v214
    v_and_b32 v134, 0xffff0000, v214
    v_lshlrev_b32 v223, 16, v215
    v_and_b32 v135, 0xffff0000, v215
    s_waitcnt lgkmcnt(4)
    v_mfma_f32_16x16x32_bf16 v[168:171], v[136:139], v[16:19], 0
    s_add_u32 m0, s58, 0
    s_add_u32 s59, s57, 0
    buffer_load_dwordx4 v252, s[20:23], s59 offen offset:0 lds
    s_lshl_b32 s50, s38, 6
    s_lshl_b32 s51, s36, 4
    v_mfma_f32_16x16x32_bf16 v[176:179], v[152:155], v[16:19], 0
    s_add_u32 s50, s50, s51
    v_add_u32 v7, s50, v2
    v_mfma_f32_16x16x32_bf16 v[172:175], v[144:147], v[16:19], 0
    v_cvt_f32_u32 v7, v7
    v_mul_f32 v10, 0xbb000000, v7
    v_mfma_f32_16x16x32_bf16 v[180:183], v[160:163], v[16:19], 0
    v_lshlrev_b32 v11, 2, v3
    v_cvt_f32_u32 v11, v11
    v_mfma_f32_16x16x32_bf16 v[168:171], v[152:155], v[24:27], v[168:171]
    buffer_load_dwordx4 v253, s[20:23], s59 offen offset:1024 lds
    v_mul_f32 v11, v11, v10
    v_mul_f32 v8, 0x41500000, v10
    v_mfma_f32_16x16x32_bf16 v[176:179], v[136:139], v[32:35], v[176:179]
    v_mul_f32 v7, -0.5, v7
    v_cmp_eq_u32 vcc, 0, v3
    v_mfma_f32_16x16x32_bf16 v[172:175], v[160:163], v[24:27], v[172:175]
    s_nop 0
    v_cndmask_b32 v7, v11, v7, vcc
    s_lshl_b32 s50, s36, 10
    v_mfma_f32_16x16x32_bf16 v[180:183], v[144:147], v[32:35], v[180:183]
    v_add_u32 v13, s50, v4
    v_cos_f32 v80, v7
    s_waitcnt lgkmcnt(0)
    v_mfma_f32_16x16x32_bf16 v[168:171], v[140:143], v[20:23], v[168:171]
    s_add_u32 s59, s57, 14336
    buffer_load_dwordx4 v252, s[20:23], s59 offen offset:2048 lds
    v_sin_f32 v81, v7
    v_mfma_f32_16x16x32_bf16 v[176:179], v[156:159], v[20:23], v[176:179]
    v_add_f32 v11, v11, v10
    v_cos_f32 v82, v11
    v_mfma_f32_16x16x32_bf16 v[172:175], v[148:151], v[20:23], v[172:175]
    v_sin_f32 v83, v11
    v_mfma_f32_16x16x32_bf16 v[180:183], v[164:167], v[20:23], v[180:183]
    v_add_f32 v11, v11, v10
    v_cos_f32 v84, v11
    v_mfma_f32_16x16x32_bf16 v[168:171], v[156:159], v[28:31], v[168:171]
    buffer_load_dwordx4 v253, s[20:23], s59 offen offset:3072 lds
    v_sin_f32 v85, v11
    v_mfma_f32_16x16x32_bf16 v[176:179], v[140:143], v[36:39], v[176:179]
    v_add_f32 v11, v11, v10
    v_cos_f32 v86, v11
    v_mfma_f32_16x16x32_bf16 v[172:175], v[164:167], v[28:31], v[172:175]
    v_sin_f32 v87, v11
    v_mfma_f32_16x16x32_bf16 v[180:183], v[148:151], v[36:39], v[180:183]
    v_add_f32 v11, v11, v8
    v_cvt_pk_bf16_f32 v88, v80, v81
    v_cvt_pk_bf16_f32 v89, v82, v83
    v_cvt_pk_bf16_f32 v90, v84, v85
    s_add_u32 m0, s58, 4096
    s_add_u32 s59, s57, 32768
    buffer_load_dwordx4 v252, s[20:23], s59 offen offset:0 lds
    v_cvt_pk_bf16_f32 v91, v86, v87
    ds_write_b128 v13, v[88:91] offset:0
    v_cos_f32 v92, v11
    v_pk_mul_f32 v[112:113], v[168:169], v[64:65]
    v_pk_mul_f32 v[120:121], v[176:177], v[64:65]
    v_pk_fma_f32 v[112:113], v[176:177], v[72:73], v[112:113]
    v_pk_fma_f32 v[120:121], v[168:169], v[72:73], v[120:121] neg_lo:[1,0,0] neg_hi:[1,0,0]
    v_pk_mul_f32 v[114:115], v[170:171], v[66:67]
    v_pk_mul_f32 v[122:123], v[178:179], v[66:67]
    v_pk_fma_f32 v[114:115], v[178:179], v[74:75], v[114:115]
    v_pk_fma_f32 v[122:123], v[170:171], v[74:75], v[122:123] neg_lo:[1,0,0] neg_hi:[1,0,0]
    v_pk_mul_f32 v[116:117], v[172:173], v[68:69]
    v_pk_mul_f32 v[124:125], v[180:181], v[68:69]
    v_pk_fma_f32 v[116:117], v[180:181], v[76:77], v[116:117]
    v_pk_fma_f32 v[124:125], v[172:173], v[76:77], v[124:125] neg_lo:[1,0,0] neg_hi:[1,0,0]
    v_pk_mul_f32 v[118:119], v[174:175], v[70:71]
    v_pk_mul_f32 v[126:127], v[182:183], v[70:71]
    v_pk_fma_f32 v[118:119], v[182:183], v[78:79], v[118:119]
    v_pk_fma_f32 v[126:127], v[174:175], v[78:79], v[126:127] neg_lo:[1,0,0] neg_hi:[1,0,0]
    v_cvt_pk_bf16_f32 v184, v112, v113
    v_cvt_pk_bf16_f32 v188, v120, v121
    v_cvt_pk_bf16_f32 v185, v114, v115
    buffer_load_dwordx4 v253, s[20:23], s59 offen offset:1024 lds
    v_cvt_pk_bf16_f32 v189, v122, v123
    v_cvt_pk_bf16_f32 v186, v116, v117
    v_cvt_pk_bf16_f32 v190, v124, v125
    v_cvt_pk_bf16_f32 v187, v118, v119
    v_cvt_pk_bf16_f32 v191, v126, v127
    v_sin_f32 v93, v11
    v_mfma_f32_16x16x32_bf16 v[168:171], v[40:43], v[184:187], 0
    v_add_f32 v11, v11, v10
    v_cos_f32 v94, v11
    v_mfma_f32_16x16x32_bf16 v[176:179], v[40:43], v[188:191], 0
    v_sin_f32 v95, v11
    v_mfma_f32_16x16x32_bf16 v[172:175], v[44:47], v[184:187], 0
    s_add_u32 s59, s57, 47104
    buffer_load_dwordx4 v252, s[20:23], s59 offen offset:2048 lds
    v_add_f32 v11, v11, v10
    v_cos_f32 v96, v11
    v_mfma_f32_16x16x32_bf16 v[180:183], v[44:47], v[188:191], 0
    v_sin_f32 v97, v11
    v_mfma_f32_16x16x32_bf16 v[168:171], v[48:51], v[188:191], v[168:171]
    v_add_f32 v11, v11, v10
    v_cos_f32 v98, v11
    v_mfma_f32_16x16x32_bf16 v[176:179], v[56:59], v[184:187], v[176:179]
    v_sin_f32 v99, v11
    v_mfma_f32_16x16x32_bf16 v[172:175], v[52:55], v[188:191], v[172:175]
    buffer_load_dwordx4 v253, s[20:23], s59 offen offset:3072 lds
    v_add_f32 v11, v11, v8
    v_cvt_pk_bf16_f32 v100, v92, v93
    v_mfma_f32_16x16x32_bf16 v[180:183], v[60:63], v[184:187], v[180:183]
    v_cvt_pk_bf16_f32 v101, v94, v95
    v_cvt_pk_bf16_f32 v102, v96, v97
    v_cvt_pk_bf16_f32 v103, v98, v99
    ds_write_b128 v13, v[100:103] offset:4096
    v_cos_f32 v80, v11
    v_sin_f32 v81, v11
    v_pk_mul_f32 v[112:113], v[168:169], v[216:217]
    v_pk_mul_f32 v[120:121], v[176:177], v[216:217]
    v_pk_fma_f32 v[112:113], v[176:177], v[128:129], v[112:113] neg_lo:[1,0,0] neg_hi:[1,0,0]
    v_pk_fma_f32 v[120:121], v[168:169], v[128:129], v[120:121]
    v_pk_mul_f32 v[114:115], v[170:171], v[218:219]
    v_pk_mul_f32 v[122:123], v[178:179], v[218:219]
    v_pk_fma_f32 v[114:115], v[178:179], v[130:131], v[114:115] neg_lo:[1,0,0] neg_hi:[1,0,0]
    v_pk_fma_f32 v[122:123], v[170:171], v[130:131], v[122:123]
    v_pk_mul_f32 v[116:117], v[172:173], v[220:221]
    s_add_u32 m0, s58, 8192
    s_add_u32 s59, s57, 65536
    buffer_load_dwordx4 v252, s[20:23], s59 offen offset:0 lds
    v_pk_mul_f32 v[124:125], v[180:181], v[220:221]
    v_pk_fma_f32 v[116:117], v[180:181], v[132:133], v[116:117] neg_lo:[1,0,0] neg_hi:[1,0,0]
    v_pk_fma_f32 v[124:125], v[172:173], v[132:133], v[124:125]
    v_pk_mul_f32 v[118:119], v[174:175], v[222:223]
    v_pk_mul_f32 v[126:127], v[182:183], v[222:223]
    v_pk_fma_f32 v[118:119], v[182:183], v[134:135], v[118:119] neg_lo:[1,0,0] neg_hi:[1,0,0]
    v_pk_fma_f32 v[126:127], v[174:175], v[134:135], v[126:127]
    v_cvt_pk_bf16_f32 v184, v112, v113
    v_cvt_pk_bf16_f32 v188, v120, v121
    v_cvt_pk_bf16_f32 v185, v114, v115
    v_cvt_pk_bf16_f32 v189, v122, v123
    v_cvt_pk_bf16_f32 v186, v116, v117
    v_cvt_pk_bf16_f32 v190, v124, v125
    v_cvt_pk_bf16_f32 v187, v118, v119
    v_cvt_pk_bf16_f32 v191, v126, v127
    v_add_f32 v11, v11, v10
    v_cos_f32 v82, v11
    v_mfma_f32_16x16x32_bf16 v[168:171], v[40:43], v[184:187], 0
    v_sin_f32 v83, v11
    buffer_load_dwordx4 v253, s[20:23], s59 offen offset:1024 lds
    v_mfma_f32_16x16x32_bf16 v[176:179], v[40:43], v[188:191], 0
    v_add_f32 v11, v11, v10
    v_cos_f32 v84, v11
    v_mfma_f32_16x16x32_bf16 v[172:175], v[44:47], v[184:187], 0
    v_sin_f32 v85, v11
    v_mfma_f32_16x16x32_bf16 v[180:183], v[44:47], v[188:191], 0
    v_add_f32 v11, v11, v10
    v_cos_f32 v86, v11
    v_mfma_f32_16x16x32_bf16 v[168:171], v[56:59], v[188:191], v[168:171]
    s_add_u32 s59, s57, 79872
    buffer_load_dwordx4 v252, s[20:23], s59 offen offset:2048 lds
    v_sin_f32 v87, v11
    v_mfma_f32_16x16x32_bf16 v[176:179], v[48:51], v[184:187], v[176:179]
    v_add_f32 v11, v11, v8
    v_cvt_pk_bf16_f32 v88, v80, v81
    v_mfma_f32_16x16x32_bf16 v[172:175], v[60:63], v[188:191], v[172:175]
    v_cvt_pk_bf16_f32 v89, v82, v83
    v_cvt_pk_bf16_f32 v90, v84, v85
    v_mfma_f32_16x16x32_bf16 v[180:183], v[52:55], v[184:187], v[180:183]
    v_cvt_pk_bf16_f32 v91, v86, v87
    ds_write_b128 v13, v[88:91] offset:8192
    v_cos_f32 v92, v11
    v_sin_f32 v93, v11
    buffer_load_dwordx4 v253, s[20:23], s59 offen offset:3072 lds
    v_add_f32 v11, v11, v10
    v_cos_f32 v94, v11
    v_pk_mul_f32 v[112:113], v[168:169], v[64:65]
    v_pk_mul_f32 v[120:121], v[176:177], v[64:65]
    v_pk_fma_f32 v[112:113], v[176:177], v[72:73], v[112:113] neg_lo:[1,0,0] neg_hi:[1,0,0]
    v_pk_fma_f32 v[120:121], v[168:169], v[72:73], v[120:121]
    v_pk_mul_f32 v[114:115], v[170:171], v[66:67]
    v_pk_mul_f32 v[122:123], v[178:179], v[66:67]
    v_pk_fma_f32 v[114:115], v[178:179], v[74:75], v[114:115] neg_lo:[1,0,0] neg_hi:[1,0,0]
    v_pk_fma_f32 v[122:123], v[170:171], v[74:75], v[122:123]
    v_pk_mul_f32 v[116:117], v[172:173], v[68:69]
    v_pk_mul_f32 v[124:125], v[180:181], v[68:69]
    v_pk_fma_f32 v[116:117], v[180:181], v[76:77], v[116:117] neg_lo:[1,0,0] neg_hi:[1,0,0]
    v_pk_fma_f32 v[124:125], v[172:173], v[76:77], v[124:125]
    v_pk_mul_f32 v[118:119], v[174:175], v[70:71]
    v_pk_mul_f32 v[126:127], v[182:183], v[70:71]
    v_pk_fma_f32 v[118:119], v[182:183], v[78:79], v[118:119] neg_lo:[1,0,0] neg_hi:[1,0,0]
    v_pk_fma_f32 v[126:127], v[174:175], v[78:79], v[126:127]
    v_cvt_pk_bf16_f32 v184, v112, v113
    v_cvt_pk_bf16_f32 v188, v120, v121
    v_cvt_pk_bf16_f32 v185, v114, v115
    v_cvt_pk_bf16_f32 v189, v122, v123
    s_add_u32 m0, s58, 12288
    s_add_u32 s59, s57, 114688
    buffer_load_dwordx4 v252, s[20:23], s59 offen offset:0 lds
    v_cvt_pk_bf16_f32 v186, v116, v117
    v_cvt_pk_bf16_f32 v190, v124, v125
    v_cvt_pk_bf16_f32 v187, v118, v119
    v_cvt_pk_bf16_f32 v191, v126, v127
    v_sin_f32 v95, v11
    ds_write_b64 v196, v[184:185] offset:0
    ds_write_b64 v197, v[186:187] offset:0
    ds_write_b64 v196, v[188:189] offset:4096
    ds_write_b64 v197, v[190:191] offset:4096
    v_add_f32 v11, v11, v10
    v_cos_f32 v96, v11
    v_sin_f32 v97, v11
    v_add_f32 v11, v11, v10
    v_cos_f32 v98, v11
    v_sin_f32 v99, v11
    v_add_f32 v11, v11, v8
    v_cvt_pk_bf16_f32 v100, v92, v93
    v_cvt_pk_bf16_f32 v101, v94, v95
    v_cvt_pk_bf16_f32 v102, v96, v97
    v_cvt_pk_bf16_f32 v103, v98, v99
    ds_write_b128 v13, v[100:103] offset:12288
    v_cos_f32 v80, v11
    buffer_load_dwordx4 v253, s[20:23], s59 offen offset:1024 lds
    v_sin_f32 v81, v11
    s_waitcnt vmcnt(14)
    s_mov_b64 exec, 1
    buffer_store_dword v255, v254, s[24:27], s52 offen sc1
    s_mov_b64 exec, -1
    s_waitcnt lgkmcnt(1)
    s_barrier
    ds_read_b64_tr_b16 v[136:137], v198 offset:0
    ds_read_b64_tr_b16 v[138:139], v199 offset:256
    ds_read_b64_tr_b16 v[144:145], v200 offset:0
    ds_read_b64_tr_b16 v[146:147], v201 offset:256
    ds_read_b64_tr_b16 v[152:153], v198 offset:4096
    ds_read_b64_tr_b16 v[154:155], v199 offset:4352
    ds_read_b64_tr_b16 v[160:161], v200 offset:4096
    ds_read_b64_tr_b16 v[162:163], v201 offset:4352
    ds_read_b64_tr_b16 v[140:141], v198 offset:2048
    ds_read_b64_tr_b16 v[142:143], v199 offset:2304
    ds_read_b64_tr_b16 v[148:149], v200 offset:2048
    ds_read_b64_tr_b16 v[150:151], v201 offset:2304
    ds_read_b64_tr_b16 v[156:157], v198 offset:6144
    ds_read_b64_tr_b16 v[158:159], v199 offset:6400
    ds_read_b64_tr_b16 v[164:165], v200 offset:6144
    ds_read_b64_tr_b16 v[166:167], v201 offset:6400
    s_lshl_b32 s61, s37, 2
    s_add_u32 s61, s61, s36
    s_lshl_b32 s61, s61, 7
    s_add_u32 s61, s61, 0x1440000
    v_and_b32 v207, 0x70, v4
    s_waitcnt lgkmcnt(8)
    v_mfma_f32_16x16x32_bf16 v[168:171], v[16:19], v[136:139], 0
    v_add_f32 v11, v11, v10
    v_cos_f32 v82, v11
    v_mfma_f32_16x16x32_bf16 v[176:179], v[16:19], v[152:155], 0
    v_sin_f32 v83, v11
    v_mfma_f32_16x16x32_bf16 v[172:175], v[16:19], v[144:147], 0
    v_add_f32 v11, v11, v10
    v_cos_f32 v84, v11
    v_mfma_f32_16x16x32_bf16 v[180:183], v[16:19], v[160:163], 0
    s_add_u32 s59, s57, 129024
    buffer_load_dwordx4 v252, s[20:23], s59 offen offset:2048 lds
    v_sin_f32 v85, v11
    v_mfma_f32_16x16x32_bf16 v[168:171], v[32:35], v[152:155], v[168:171]
    v_add_f32 v11, v11, v10
    v_cos_f32 v86, v11
    v_mfma_f32_16x16x32_bf16 v[176:179], v[24:27], v[136:139], v[176:179]
    v_sin_f32 v87, v11
    v_mfma_f32_16x16x32_bf16 v[172:175], v[32:35], v[160:163], v[172:175]
    v_add_f32 v11, v11, v8
    v_cvt_pk_bf16_f32 v88, v80, v81
    v_mfma_f32_16x16x32_bf16 v[180:183], v[24:27], v[144:147], v[180:183]
    buffer_load_dwordx4 v253, s[20:23], s59 offen offset:3072 lds
    v_cvt_pk_bf16_f32 v89, v82, v83
    v_cvt_pk_bf16_f32 v90, v84, v85
    s_waitcnt lgkmcnt(0)
    v_mfma_f32_16x16x32_bf16 v[168:171], v[20:23], v[140:143], v[168:171]
    v_cvt_pk_bf16_f32 v91, v86, v87
    ds_write_b128 v13, v[88:91] offset:16384
    v_mfma_f32_16x16x32_bf16 v[176:179], v[20:23], v[156:159], v[176:179]
    v_cos_f32 v92, v11
    v_mfma_f32_16x16x32_bf16 v[172:175], v[20:23], v[148:151], v[172:175]
    v_sin_f32 v93, v11
    v_mfma_f32_16x16x32_bf16 v[180:183], v[20:23], v[164:167], v[180:183]
    s_add_u32 m0, s58, 16384
    s_add_u32 s59, s57, 147456
    buffer_load_dwordx4 v252, s[20:23], s59 offen offset:0 lds
    v_add_f32 v11, v11, v10
    v_cos_f32 v94, v11
    v_mfma_f32_16x16x32_bf16 v[168:171], v[36:39], v[156:159], v[168:171]
    v_sin_f32 v95, v11
    v_mfma_f32_16x16x32_bf16 v[176:179], v[28:31], v[140:143], v[176:179]
    v_add_f32 v11, v11, v10
    v_cos_f32 v96, v11
    v_mfma_f32_16x16x32_bf16 v[172:175], v[36:39], v[164:167], v[172:175]
    v_sin_f32 v97, v11
    v_mfma_f32_16x16x32_bf16 v[180:183], v[28:31], v[148:151], v[180:183]
    buffer_load_dwordx4 v253, s[20:23], s59 offen offset:1024 lds
    v_add_f32 v11, v11, v10
    v_cos_f32 v98, v11
    v_sin_f32 v99, v11
    v_add_f32 v11, v11, v8
    v_cvt_pk_bf16_f32 v100, v92, v93
    v_cvt_pk_bf16_f32 v101, v94, v95
    v_cvt_pk_bf16_f32 v102, v96, v97
    v_cvt_pk_bf16_f32 v184, v168, v169
    v_cvt_pk_bf16_f32 v185, v170, v171
    v_cvt_pk_bf16_f32 v186, v172, v173
    v_cvt_pk_bf16_f32 v187, v174, v175
    v_cvt_pk_bf16_f32 v188, v176, v177
    v_cvt_pk_bf16_f32 v189, v178, v179
    v_cvt_pk_bf16_f32 v190, v180, v181
    v_cvt_pk_bf16_f32 v191, v182, v183
    ds_write_b64 v202, v[184:185] offset:0
    ds_write_b64 v202, v[186:187] offset:2048
    ds_write_b64 v202, v[188:189] offset:4096
    ds_write_b64 v202, v[190:191] offset:6144
    s_mul_i32 s42, s37, 56
    s_mul_i32 s50, s36, 14
    s_add_u32 s42, s42, s50
    s_lshl_b32 s42, s42, 12
    s_add_u32 s42, s42, 0xa00000
    s_and_b32 s50, s38, 0
    s_mul_i32 s50, s50, 28672
    s_sub_u32 s43, 28672, s50
    s_add_u32 s43, s43, s42
    s_add_u32 s42, s42, s50
    v_xor_b32 v192, 0x400, v13
    v_xor_b32 v6, 0x800, v13
    v_xor_b32 v15, 0xc00, v13
    s_waitcnt lgkmcnt(0)
    s_barrier
    ds_read_b128 v[112:115], v203
    ds_read_b128 v[116:119], v204 offset:1024
    s_waitcnt lgkmcnt(0)
    buffer_store_dwordx4 v[112:115], v4, s[24:27], s46 offen sc1
    buffer_store_dwordx4 v[116:119], v4, s[24:27], s46 offen offset:1024 sc1
    v_cvt_pk_bf16_f32 v103, v98, v99
    ds_write_b128 v13, v[100:103] offset:20480
    v_cos_f32 v80, v11
    v_sin_f32 v81, v11
    s_add_u32 s59, s57, 161792
    buffer_load_dwordx4 v252, s[20:23], s59 offen offset:2048 lds
    v_add_f32 v11, v11, v10
    v_cos_f32 v82, v11
    v_sin_f32 v83, v11
    v_add_f32 v11, v11, v10
    v_cos_f32 v84, v11
    v_sin_f32 v85, v11
    v_add_f32 v11, v11, v10
    v_cos_f32 v86, v11
    v_sin_f32 v87, v11
    buffer_load_dwordx4 v253, s[20:23], s59 offen offset:3072 lds
    v_add_f32 v11, v11, v8
    v_cvt_pk_bf16_f32 v88, v80, v81
    v_cvt_pk_bf16_f32 v89, v82, v83
    v_cvt_pk_bf16_f32 v90, v84, v85
    v_cvt_pk_bf16_f32 v91, v86, v87
    ds_write_b128 v13, v[88:91] offset:24576
    v_cos_f32 v92, v11
    v_sin_f32 v93, v11
    v_add_f32 v11, v11, v10
    v_cos_f32 v94, v11
    v_sin_f32 v95, v11
    s_waitcnt vmcnt(19)
    ds_read_b64_tr_b16 a[16:17], v248 offset:0
    ds_read_b64_tr_b16 a[18:19], v248 offset:2048
    ds_read_b64_tr_b16 a[20:21], v249 offset:0
    ds_read_b64_tr_b16 a[22:23], v249 offset:2048
    ds_read_b64_tr_b16 a[24:25], v250 offset:0
    ds_read_b64_tr_b16 a[26:27], v250 offset:2048
    ds_read_b64_tr_b16 a[28:29], v251 offset:0
    ds_read_b64_tr_b16 a[30:31], v251 offset:2048
    v_add_f32 v11, v11, v10
    v_cos_f32 v96, v11
    v_sin_f32 v97, v11
    v_add_f32 v11, v11, v10
    v_cos_f32 v98, v11
    v_sin_f32 v99, v11
    v_add_f32 v11, v11, v8
    v_cvt_pk_bf16_f32 v100, v92, v93
    v_cvt_pk_bf16_f32 v101, v94, v95
    v_cvt_pk_bf16_f32 v102, v96, v97
    v_cvt_pk_bf16_f32 v103, v98, v99
    s_waitcnt lgkmcnt(0)
    s_add_u32 m0, s58, 0
    s_add_u32 s59, s57, 180224
    buffer_load_dwordx4 v252, s[20:23], s59 offen offset:0 lds
    ds_write_b128 v13, v[100:103] offset:28672
    v_cos_f32 v80, v11
    v_sin_f32 v81, v11
    v_add_f32 v11, v11, v10
    v_cos_f32 v82, v11
    v_sin_f32 v83, v11
    buffer_load_dword v240, v207, s[24:27], s61 offen sc1
    v_add_f32 v11, v11, v10
    v_cos_f32 v84, v11
    v_sin_f32 v85, v11
    buffer_load_dwordx4 v253, s[20:23], s59 offen offset:1024 lds
    v_add_f32 v11, v11, v10
    v_cos_f32 v86, v11
    v_sin_f32 v87, v11
    v_add_f32 v11, v11, v8
    v_cvt_pk_bf16_f32 v88, v80, v81
    v_cvt_pk_bf16_f32 v89, v82, v83
    v_cvt_pk_bf16_f32 v90, v84, v85
    v_cvt_pk_bf16_f32 v91, v86, v87
    ds_write_b128 v13, v[88:91] offset:32768
    v_cos_f32 v92, v11
    v_sin_f32 v93, v11
    s_add_u32 s59, s57, 194560
    buffer_load_dwordx4 v252, s[20:23], s59 offen offset:2048 lds
    v_add_f32 v11, v11, v10
    v_cos_f32 v94, v11
    v_sin_f32 v95, v11
    v_add_f32 v11, v11, v10
    v_cos_f32 v96, v11
    v_sin_f32 v97, v11
    v_add_f32 v11, v11, v10
    v_cos_f32 v98, v11
    v_sin_f32 v99, v11
    buffer_load_dwordx4 v253, s[20:23], s59 offen offset:3072 lds
    v_add_f32 v11, v11, v8
    v_cvt_pk_bf16_f32 v100, v92, v93
    v_cvt_pk_bf16_f32 v101, v94, v95
    v_cvt_pk_bf16_f32 v102, v96, v97
    v_cvt_pk_bf16_f32 v103, v98, v99
    ds_write_b128 v13, v[100:103] offset:36864
    v_cos_f32 v80, v11
    v_sin_f32 v81, v11
    v_add_f32 v11, v11, v10
    v_cos_f32 v82, v11
    v_sin_f32 v83, v11
    s_waitcnt vmcnt(20)
    ds_read_b64_tr_b16 a[32:33], v248 offset:4096
    ds_read_b64_tr_b16 a[34:35], v248 offset:6144
    ds_read_b64_tr_b16 a[36:37], v249 offset:4096
    ds_read_b64_tr_b16 a[38:39], v249 offset:6144
    ds_read_b64_tr_b16 a[40:41], v250 offset:4096
    ds_read_b64_tr_b16 a[42:43], v250 offset:6144
    ds_read_b64_tr_b16 a[44:45], v251 offset:4096
    ds_read_b64_tr_b16 a[46:47], v251 offset:6144
    v_add_f32 v11, v11, v10
    v_cos_f32 v84, v11
    v_sin_f32 v85, v11
    v_add_f32 v11, v11, v10
    v_cos_f32 v86, v11
    v_sin_f32 v87, v11
    s_waitcnt lgkmcnt(0)
    s_add_u32 m0, s58, 4096
    s_add_u32 s59, s57, 98304
    buffer_load_dwordx4 v252, s[20:23], s59 offen offset:0 lds
    buffer_load_dwordx4 v253, s[20:23], s59 offen offset:1024 lds
    s_add_u32 s59, s57, 210944
    buffer_load_dwordx4 v252, s[20:23], s59 offen offset:2048 lds
    buffer_load_dwordx4 v253, s[20:23], s59 offen offset:3072 lds
    s_waitcnt vmcnt(20)
    ds_read_b64_tr_b16 a[48:49], v248 offset:8192
    ds_read_b64_tr_b16 a[50:51], v248 offset:10240
    ds_read_b64_tr_b16 a[52:53], v249 offset:8192
    ds_read_b64_tr_b16 a[54:55], v249 offset:10240
    ds_read_b64_tr_b16 a[56:57], v250 offset:8192
    ds_read_b64_tr_b16 a[58:59], v250 offset:10240
    ds_read_b64_tr_b16 a[60:61], v251 offset:8192
    ds_read_b64_tr_b16 a[62:63], v251 offset:10240
    s_waitcnt vmcnt(15)
    ds_read_b64_tr_b16 a[64:65], v248 offset:12288
    ds_read_b64_tr_b16 a[66:67], v248 offset:14336
    ds_read_b64_tr_b16 a[68:69], v249 offset:12288
    ds_read_b64_tr_b16 a[70:71], v249 offset:14336
    ds_read_b64_tr_b16 a[72:73], v250 offset:12288
    ds_read_b64_tr_b16 a[74:75], v250 offset:14336
    ds_read_b64_tr_b16 a[76:77], v251 offset:12288
    ds_read_b64_tr_b16 a[78:79], v251 offset:14336
    s_waitcnt vmcnt(9)
    ds_read_b64_tr_b16 a[80:81], v248 offset:16384
    ds_read_b64_tr_b16 a[82:83], v248 offset:18432
    ds_read_b64_tr_b16 a[84:85], v249 offset:16384
    ds_read_b64_tr_b16 a[86:87], v249 offset:18432
    ds_read_b64_tr_b16 a[88:89], v250 offset:16384
    ds_read_b64_tr_b16 a[90:91], v250 offset:18432
    ds_read_b64_tr_b16 a[92:93], v251 offset:16384
    ds_read_b64_tr_b16 a[94:95], v251 offset:18432
    s_waitcnt vmcnt(4)
    ds_read_b64_tr_b16 a[96:97], v248 offset:0
    ds_read_b64_tr_b16 a[98:99], v248 offset:2048
    ds_read_b64_tr_b16 a[100:101], v249 offset:0
    ds_read_b64_tr_b16 a[102:103], v249 offset:2048
    ds_read_b64_tr_b16 a[104:105], v250 offset:0
    ds_read_b64_tr_b16 a[106:107], v250 offset:2048
    ds_read_b64_tr_b16 a[108:109], v251 offset:0
    ds_read_b64_tr_b16 a[110:111], v251 offset:2048
    s_waitcnt vmcnt(0)
    ds_read_b64_tr_b16 a[112:113], v248 offset:4096
    ds_read_b64_tr_b16 a[114:115], v248 offset:6144
    ds_read_b64_tr_b16 a[116:117], v249 offset:4096
    ds_read_b64_tr_b16 a[118:119], v249 offset:6144
    ds_read_b64_tr_b16 a[120:121], v250 offset:4096
    ds_read_b64_tr_b16 a[122:123], v250 offset:6144
    ds_read_b64_tr_b16 a[124:125], v251 offset:4096
    ds_read_b64_tr_b16 a[126:127], v251 offset:6144
    s_waitcnt vmcnt(7)
    v_cmp_ne_u32 vcc, s3, v240
    s_cbranch_vccz L_pok_hf
    s_mov_b32 s63, 20000
L_poll_hf:
    s_sleep 16
    buffer_load_dword v240, v207, s[24:27], s61 offen sc1
    s_waitcnt vmcnt(0)
    v_cmp_ne_u32 vcc, s3, v240
    s_sub_u32 s63, s63, 1
    s_cselect_b64 vcc, 0, vcc
    s_nop 4
    s_cbranch_vccnz L_poll_hf
L_pok_hf:
    v_mov_b32 v5, v192
    s_add_u32 s45, s42, 0
    buffer_load_dwordx4 v[120:123], v13, s[24:27], s45 offen sc1
    buffer_load_dwordx4 v[124:127], v5, s[24:27], s45 offen sc1
    buffer_load_dwordx4 v[128:131], v6, s[24:27], s45 offen sc1
    buffer_load_dwordx4 v[132:135], v15, s[24:27], s45 offen sc1
    s_add_u32 s45, s42, 4096
    buffer_load_dwordx4 v[136:139], v13, s[24:27], s45 offen sc1
    buffer_load_dwordx4 v[140:143], v5, s[24:27], s45 offen sc1
    buffer_load_dwordx4 v[144:147], v6, s[24:27], s45 offen sc1
    buffer_load_dwordx4 v[148:151], v15, s[24:27], s45 offen sc1
    s_add_u32 s45, s42, 8192
    buffer_load_dwordx4 v[152:155], v13, s[24:27], s45 offen sc1
    buffer_load_dwordx4 v[156:159], v5, s[24:27], s45 offen sc1
    buffer_load_dwordx4 v[160:163], v6, s[24:27], s45 offen sc1
    buffer_load_dwordx4 v[164:167], v15, s[24:27], s45 offen sc1
    s_lshr_b32 s50, s36, 1
    s_lshl_b32 s50, s50, 10
    v_add_u32 v244, s50, v4
    v_xor_b32 v245, 0x800, v244
    v_xor_b32 v246, 0x400, v244
    v_xor_b32 v247, 0xc00, v244
    s_lshl_b32 s53, s2, 4
    s_add_u32 s53, s53, 0x1460000
    s_cmp_eq_u32 s36, 0
    s_cselect_b32 s53, s53, 0x7ff00000
    s_waitcnt vmcnt(23) lgkmcnt(0)
    s_barrier
    s_mov_b64 exec, 1
    buffer_store_dword v255, v254, s[24:27], s53 offen sc1
    s_mov_b64 exec, -1
    v_add_f32 v11, v11, v8
    v_cvt_pk_bf16_f32 v88, v80, v81
    v_cvt_pk_bf16_f32 v89, v82, v83
    v_cvt_pk_bf16_f32 v90, v84, v85
    v_cvt_pk_bf16_f32 v91, v86, v87
    ds_write_b128 v13, v[88:91] offset:40960
    v_cos_f32 v92, v11
    v_sin_f32 v93, v11
    v_add_f32 v11, v11, v10
    v_cos_f32 v94, v11
    v_sin_f32 v95, v11
    s_add_u32 s45, s42, 12288
    buffer_load_dwordx4 v[168:171], v13, s[24:27], s45 offen sc1
    v_add_f32 v11, v11, v10
    v_cos_f32 v96, v11
    v_sin_f32 v97, v11
    v_add_f32 v11, v11, v10
    v_cos_f32 v98, v11
    v_sin_f32 v99, v11
    v_add_f32 v11, v11, v8
    v_cvt_pk_bf16_f32 v100, v92, v93
    v_cvt_pk_bf16_f32 v101, v94, v95
    v_cvt_pk_bf16_f32 v102, v96, v97
    v_cvt_pk_bf16_f32 v103, v98, v99
    buffer_load_dwordx4 v[172:175], v5, s[24:27], s45 offen sc1
    ds_write_b128 v13, v[100:103] offset:45056
    v_cos_f32 v80, v11
    v_sin_f32 v81, v11
    v_add_f32 v11, v11, v10
    v_cos_f32 v82, v11
    v_sin_f32 v83, v11
    v_add_f32 v11, v11, v10
    v_cos_f32 v84, v11
    v_sin_f32 v85, v11
    buffer_load_dwordx4 v[176:179], v6, s[24:27], s45 offen sc1
    v_add_f32 v11, v11, v10
    v_cos_f32 v86, v11
    v_sin_f32 v87, v11
    v_add_f32 v11, v11, v8
    v_cvt_pk_bf16_f32 v88, v80, v81
    v_cvt_pk_bf16_f32 v89, v82, v83
    v_cvt_pk_bf16_f32 v90, v84, v85
    v_cvt_pk_bf16_f32 v91, v86, v87
    ds_write_b128 v13, v[88:91] offset:49152
    v_cos_f32 v92, v11
    v_sin_f32 v93, v11
    buffer_load_dwordx4 v[180:183], v15, s[24:27], s45 offen sc1
    s_waitcnt vmcnt(13)
    v_mfma_f32_16x16x32_bf16 v[16:19], a[144:147], v[120:123], 0
    v_add_f32 v11, v11, v10
    v_cos_f32 v94, v11
    v_mfma_f32_16x16x32_bf16 v[32:35], a[144:147], v[124:127], 0
    v_sin_f32 v95, v11
    s_add_u32 s45, s42, 16384
    buffer_load_dwordx4 v[184:187], v13, s[24:27], s45 offen sc1
    v_mfma_f32_16x16x32_bf16 v[48:51], a[144:147], v[128:131], 0
    v_add_f32 v11, v11, v10
    v_cos_f32 v96, v11
    v_mfma_f32_16x16x32_bf16 v[64:67], a[144:147], v[132:135], 0
    v_sin_f32 v97, v11
    buffer_load_dwordx4 v[188:191], v5, s[24:27], s45 offen sc1
    v_mfma_f32_16x16x32_bf16 v[20:23], a[148:151], v[120:123], 0
    v_add_f32 v11, v11, v10
    v_cos_f32 v98, v11
    v_mfma_f32_16x16x32_bf16 v[36:39], a[148:151], v[124:127], 0
    v_sin_f32 v99, v11
    buffer_load_dwordx4 v[192:195], v6, s[24:27], s45 offen sc1
    v_mfma_f32_16x16x32_bf16 v[52:55], a[148:151], v[128:131], 0
    v_add_f32 v11, v11, v8
    v_cvt_pk_bf16_f32 v100, v92, v93
    v_mfma_f32_16x16x32_bf16 v[68:71], a[148:151], v[132:135], 0
    v_cvt_pk_bf16_f32 v101, v94, v95
    v_cvt_pk_bf16_f32 v102, v96, v97
    buffer_load_dwordx4 v[196:199], v15, s[24:27], s45 offen sc1
    v_mfma_f32_16x16x32_bf16 v[24:27], a[152:155], v[120:123], 0
    v_cvt_pk_bf16_f32 v103, v98, v99
    ds_write_b128 v13, v[100:103] offset:53248
    v_mfma_f32_16x16x32_bf16 v[40:43], a[152:155], v[124:127], 0
    v_cos_f32 v80, v11
    s_add_u32 s45, s42, 20480
    buffer_load_dwordx4 v[200:203], v13, s[24:27], s45 offen sc1
    v_mfma_f32_16x16x32_bf16 v[56:59], a[152:155], v[128:131], 0
    v_sin_f32 v81, v11
    v_mfma_f32_16x16x32_bf16 v[72:75], a[152:155], v[132:135], 0
    v_add_f32 v11, v11, v10
    v_cos_f32 v82, v11
    buffer_load_dwordx4 v[204:207], v5, s[24:27], s45 offen sc1
    v_mfma_f32_16x16x32_bf16 v[28:31], a[156:159], v[120:123], 0
    v_sin_f32 v83, v11
    v_mfma_f32_16x16x32_bf16 v[44:47], a[156:159], v[124:127], 0
    v_add_f32 v11, v11, v10
    v_cos_f32 v84, v11
    buffer_load_dwordx4 v[208:211], v6, s[24:27], s45 offen sc1
    v_mfma_f32_16x16x32_bf16 v[60:63], a[156:159], v[128:131], 0
    v_sin_f32 v85, v11
    v_mfma_f32_16x16x32_bf16 v[76:79], a[156:159], v[132:135], 0
    v_add_f32 v11, v11, v10
    v_cos_f32 v86, v11
    buffer_load_dwordx4 v[212:215], v15, s[24:27], s45 offen sc1
    s_waitcnt vmcnt(17)
    v_mfma_f32_16x16x32_bf16 v[16:19], a[160:163], v[136:139], v[16:19]
    v_sin_f32 v87, v11
    v_mfma_f32_16x16x32_bf16 v[32:35], a[160:163], v[140:143], v[32:35]
    v_add_f32 v11, v11, v8
    v_cvt_pk_bf16_f32 v88, v80, v81
    s_add_u32 s45, s42, 24576
    buffer_load_dwordx4 v[120:123], v244, s[24:27], s45 offen sc1
    v_mfma_f32_16x16x32_bf16 v[48:51], a[160:163], v[144:147], v[48:51]
    v_cvt_pk_bf16_f32 v89, v82, v83
    v_cvt_pk_bf16_f32 v90, v84, v85
    v_mfma_f32_16x16x32_bf16 v[64:67], a[160:163], v[148:151], v[64:67]
    v_cvt_pk_bf16_f32 v91, v86, v87
    ds_write_b128 v13, v[88:91] offset:57344
    buffer_load_dwordx4 v[124:127], v245, s[24:27], s45 offen sc1
    v_mfma_f32_16x16x32_bf16 v[20:23], a[164:167], v[136:139], v[20:23]
    v_cos_f32 v92, v11
    v_mfma_f32_16x16x32_bf16 v[36:39], a[164:167], v[140:143], v[36:39]
    v_sin_f32 v93, v11
    buffer_load_dwordx4 v[128:131], v246, s[24:27], s45 offen sc1
    v_mfma_f32_16x16x32_bf16 v[52:55], a[164:167], v[144:147], v[52:55]
    v_add_f32 v11, v11, v10
    v_cos_f32 v94, v11
    v_mfma_f32_16x16x32_bf16 v[68:71], a[164:167], v[148:151], v[68:71]
    v_sin_f32 v95, v11
    buffer_load_dwordx4 v[132:135], v247, s[24:27], s45 offen sc1
    v_mfma_f32_16x16x32_bf16 v[24:27], a[168:171], v[136:139], v[24:27]
    v_add_f32 v11, v11, v10
    v_cos_f32 v96, v11
    v_mfma_f32_16x16x32_bf16 v[40:43], a[168:171], v[140:143], v[40:43]
    v_sin_f32 v97, v11
    v_mfma_f32_16x16x32_bf16 v[56:59], a[168:171], v[144:147], v[56:59]
    v_add_f32 v11, v11, v10
    v_cos_f32 v98, v11
    v_mfma_f32_16x16x32_bf16 v[72:75], a[168:171], v[148:151], v[72:75]
    v_sin_f32 v99, v11
    v_mfma_f32_16x16x32_bf16 v[28:31], a[172:175], v[136:139], v[28:31]
    v_cvt_pk_bf16_f32 v100, v92, v93
    v_cvt_pk_bf16_f32 v101, v94, v95
    v_mfma_f32_16x16x32_bf16 v[44:47], a[172:175], v[140:143], v[44:47]
    v_cvt_pk_bf16_f32 v102, v96, v97
    v_cvt_pk_bf16_f32 v103, v98, v99
    v_mfma_f32_16x16x32_bf16 v[60:63], a[172:175], v[144:147], v[60:63]
    ds_write_b128 v13, v[100:103] offset:61440
    v_add_u32 v8, 31744, v14
    v_mfma_f32_16x16x32_bf16 v[76:79], a[172:175], v[148:151], v[76:79]
    v_add_u32 v9, 63488, v14
    v_add_u32 v10, 95232, v14
    s_waitcnt vmcnt(17)
    v_mfma_f32_16x16x32_bf16 v[16:19], a[176:179], v[152:155], v[16:19]
    s_lshl_b32 s46, s36, 19
    s_lshl_b32 s50, s37, 7
    v_mfma_f32_16x16x32_bf16 v[32:35], a[176:179], v[156:159], v[32:35]
    s_add_u32 s46, s46, s50
    s_add_u32 s46, s46, 0x600000
    s_add_u32 s45, s43, 0
    buffer_load_dwordx4 v[136:139], v13, s[24:27], s45 offen sc1
    v_mfma_f32_16x16x32_bf16 v[48:51], a[176:179], v[160:163], v[48:51]
    s_lshl_b32 s47, s36, 14
    s_add_u32 s47, s47, 65536
    v_mfma_f32_16x16x32_bf16 v[64:67], a[176:179], v[164:167], v[64:67]
    s_and_b32 s41, s38, 3
    v_lshrrev_b32 v11, 3, v1
    buffer_load_dwordx4 v[140:143], v5, s[24:27], s45 offen sc1
    v_mfma_f32_16x16x32_bf16 v[20:23], a[180:183], v[152:155], v[20:23]
    v_lshlrev_b32 v11, 15, v11
    v_and_b32 v7, 0x70, v4
    v_mfma_f32_16x16x32_bf16 v[36:39], a[180:183], v[156:159], v[36:39]
    v_add_u32 v7, v7, v11
    v_add_u32 v11, v11, v0
    buffer_load_dwordx4 v[144:147], v6, s[24:27], s45 offen sc1
    v_mfma_f32_16x16x32_bf16 v[52:55], a[180:183], v[160:163], v[52:55]
    s_lshl_b32 s48, s36, 19
    s_lshl_b32 s50, s37, 10
    v_mfma_f32_16x16x32_bf16 v[68:71], a[180:183], v[164:167], v[68:71]
    s_add_u32 s48, s48, s50
    s_lshl_b32 s50, s38, 7
    buffer_load_dwordx4 v[148:151], v15, s[24:27], s45 offen sc1
    v_mfma_f32_16x16x32_bf16 v[24:27], a[184:187], v[152:155], v[24:27]
    s_add_u32 s48, s48, s50
    s_add_u32 s49, s48, 0x40000
    v_mfma_f32_16x16x32_bf16 v[40:43], a[184:187], v[156:159], v[40:43]
    s_lshl_b32 s60, s36, 11
    s_add_u32 s60, s60, 131072
    v_mfma_f32_16x16x32_bf16 v[56:59], a[184:187], v[160:163], v[56:59]
    v_add_u32 v12, s60, v12
    s_mov_b32 s54, 0x1460000
    v_mfma_f32_16x16x32_bf16 v[72:75], a[184:187], v[164:167], v[72:75]
    s_mov_b32 s55, 0x1460400
    s_mov_b32 s56, 0x1460800
    v_mfma_f32_16x16x32_bf16 v[28:31], a[188:191], v[152:155], v[28:31]
    s_mov_b32 s57, 0x1460c00
    v_xor_b32 v252, 64, v11
    v_mfma_f32_16x16x32_bf16 v[44:47], a[188:191], v[156:159], v[44:47]
    s_mov_b32 m0, s60
    s_nop 0
    buffer_load_dwordx4 v11, s[4:7], s48 offen lds
    s_add_u32 m0, s60, 1024
    s_nop 0
    buffer_load_dwordx4 v252, s[4:7], s49 offen lds
    v_mfma_f32_16x16x32_bf16 v[60:63], a[188:191], v[160:163], v[60:63]
    v_bfe_u32 v11, v1, 3, 2
    v_xor_b32 v11, s36, v11
    v_mfma_f32_16x16x32_bf16 v[76:79], a[188:191], v[164:167], v[76:79]
    v_lshlrev_b32 v11, 5, v11
    v_and_b32 v252, 3, v1
    v_lshl_add_u32 v11, v252, 3, v11
    v_bfe_u32 v252, v1, 2, 2
    v_lshl_add_u32 v252, v3, 3, v252
    v_lshl_add_u32 v11, v252, 7, v11
    v_add_u32 v11, 65536, v11
    v_lshrrev_b32 v248, 1, v2
    v_lshrrev_b32 v252, 1, v3
    v_xor_b32 v248, v248, v252
    v_lshlrev_b32 v248, 4, v248
    v_and_b32 v252, 1, v3
    v_lshl_add_u32 v248, v252, 3, v248
    v_lshl_add_u32 v248, v2, 7, v248
    v_add_u32 v248, s60, v248
    v_xor_b32 v249, 32, v248
    v_xor_b32 v250, 64, v248
    v_xor_b32 v251, 0x60, v248
    v_xor_b32 v253, 64, v12
    s_lshl_b32 s44, s36, 14
    v_add_u32 v96, s44, v4
    v_xor_b32 v97, 0x4000, v96
    v_xor_b32 v98, 0x9000, v96
    v_xor_b32 v99, 0xe000, v96
    buffer_load_dword v240, v4, s[24:27], s54 offen sc1
    buffer_load_dword v241, v4, s[24:27], s55 offen sc1
    buffer_load_dword v242, v4, s[24:27], s56 offen sc1
    buffer_load_dword v243, v4, s[24:27], s57 offen sc1
    s_waitcnt vmcnt(22)
    v_mfma_f32_16x16x32_bf16 v[16:19], a[192:195], v[168:171], v[16:19]
    v_mfma_f32_16x16x32_bf16 v[32:35], a[192:195], v[172:175], v[32:35]
    s_add_u32 s45, s43, 4096
    buffer_load_dwordx4 v[152:155], v13, s[24:27], s45 offen sc1
    v_mfma_f32_16x16x32_bf16 v[48:51], a[192:195], v[176:179], v[48:51]
    v_mfma_f32_16x16x32_bf16 v[64:67], a[192:195], v[180:183], v[64:67]
    buffer_load_dwordx4 v[156:159], v5, s[24:27], s45 offen sc1
    v_mfma_f32_16x16x32_bf16 v[20:23], a[196:199], v[168:171], v[20:23]
    v_mfma_f32_16x16x32_bf16 v[36:39], a[196:199], v[172:175], v[36:39]
    buffer_load_dwordx4 v[160:163], v6, s[24:27], s45 offen sc1
    v_mfma_f32_16x16x32_bf16 v[52:55], a[196:199], v[176:179], v[52:55]
    v_mfma_f32_16x16x32_bf16 v[68:71], a[196:199], v[180:183], v[68:71]
    buffer_load_dwordx4 v[164:167], v15, s[24:27], s45 offen sc1
    v_mfma_f32_16x16x32_bf16 v[24:27], a[200:203], v[168:171], v[24:27]
    v_mfma_f32_16x16x32_bf16 v[40:43], a[200:203], v[172:175], v[40:43]
    v_mfma_f32_16x16x32_bf16 v[56:59], a[200:203], v[176:179], v[56:59]
    v_mfma_f32_16x16x32_bf16 v[72:75], a[200:203], v[180:183], v[72:75]
    v_mfma_f32_16x16x32_bf16 v[28:31], a[204:207], v[168:171], v[28:31]
    v_mfma_f32_16x16x32_bf16 v[44:47], a[204:207], v[172:175], v[44:47]
    v_mfma_f32_16x16x32_bf16 v[60:63], a[204:207], v[176:179], v[60:63]
    v_mfma_f32_16x16x32_bf16 v[76:79], a[204:207], v[180:183], v[76:79]
    s_waitcnt vmcnt(22)
    v_mfma_f32_16x16x32_bf16 v[16:19], a[208:211], v[184:187], v[16:19]
    v_mfma_f32_16x16x32_bf16 v[32:35], a[208:211], v[188:191], v[32:35]
    s_add_u32 s45, s43, 8192
    buffer_load_dwordx4 v[168:171], v13, s[24:27], s45 offen sc1
    v_mfma_f32_16x16x32_bf16 v[48:51], a[208:211], v[192:195], v[48:51]
    v_mfma_f32_16x16x32_bf16 v[64:67], a[208:211], v[196:199], v[64:67]
    buffer_load_dwordx4 v[172:175], v5, s[24:27], s45 offen sc1
    v_mfma_f32_16x16x32_bf16 v[20:23], a[212:215], v[184:187], v[20:23]
    v_mfma_f32_16x16x32_bf16 v[36:39], a[212:215], v[188:191], v[36:39]
    buffer_load_dwordx4 v[176:179], v6, s[24:27], s45 offen sc1
    v_mfma_f32_16x16x32_bf16 v[52:55], a[212:215], v[192:195], v[52:55]
    v_mfma_f32_16x16x32_bf16 v[68:71], a[212:215], v[196:199], v[68:71]
    buffer_load_dwordx4 v[180:183], v15, s[24:27], s45 offen sc1
    v_mfma_f32_16x16x32_bf16 v[24:27], a[216:219], v[184:187], v[24:27]
    v_mfma_f32_16x16x32_bf16 v[40:43], a[216:219], v[188:191], v[40:43]
    v_mfma_f32_16x16x32_bf16 v[56:59], a[216:219], v[192:195], v[56:59]
    v_mfma_f32_16x16x32_bf16 v[72:75], a[216:219], v[196:199], v[72:75]
    v_mfma_f32_16x16x32_bf16 v[28:31], a[220:223], v[184:187], v[28:31]
    v_mfma_f32_16x16x32_bf16 v[44:47], a[220:223], v[188:191], v[44:47]
    v_mfma_f32_16x16x32_bf16 v[60:63], a[220:223], v[192:195], v[60:63]
    v_mfma_f32_16x16x32_bf16 v[76:79], a[220:223], v[196:199], v[76:79]
    s_waitcnt vmcnt(8)
    v_xor_b32 v241, v240, v241
    v_xor_b32 v242, v240, v242
    v_xor_b32 v243, v240, v243
    v_or_b32 v241, v241, v242
    v_or_b32 v241, v241, v243
    v_bitop3_b32 v240, v240, v255, v241 bitop3:0xbe
    v_cmp_ne_u32 vcc, 0, v240
    s_cbranch_vccz L_pok_zf
    s_mov_b32 s63, 20000
L_poll_zf:
    s_sleep 16
    buffer_load_dword v240, v4, s[24:27], s54 offen sc1
    buffer_load_dword v241, v4, s[24:27], s55 offen sc1
    buffer_load_dword v242, v4, s[24:27], s56 offen sc1
    buffer_load_dword v243, v4, s[24:27], s57 offen sc1
    s_waitcnt vmcnt(0)
    v_xor_b32 v241, v240, v241
    v_xor_b32 v242, v240, v242
    v_xor_b32 v243, v240, v243
    v_or_b32 v241, v241, v242
    v_or_b32 v241, v241, v243
    v_bitop3_b32 v240, v240, v255, v241 bitop3:0xbe
    v_cmp_ne_u32 vcc, 0, v240
    s_sub_u32 s63, s63, 1
    s_cselect_b64 vcc, 0, vcc
    s_nop 4
    s_cbranch_vccnz L_poll_zf
L_pok_zf:
    s_waitcnt vmcnt(22)
    v_mfma_f32_16x16x32_bf16 v[16:19], a[224:227], v[200:203], v[16:19]
    v_mfma_f32_16x16x32_bf16 v[32:35], a[224:227], v[204:207], v[32:35]
    s_lshl_b32 s59, s41, 12
    s_add_u32 m0, s59, s47
    s_lshl_b32 s52, s41, 17
    s_add_u32 s52, s52, s46
    s_add_u32 s41, s41, 1
    s_and_b32 s41, s41, 3
    buffer_load_dwordx4 v14, s[24:27], s52 offen offset:0 sc1 lds
    v_mfma_f32_16x16x32_bf16 v[48:51], a[224:227], v[208:211], v[48:51]
    v_mfma_f32_16x16x32_bf16 v[64:67], a[224:227], v[212:215], v[64:67]
    buffer_load_dwordx4 v8, s[24:27], s52 offen offset:1024 sc1 lds
    v_mfma_f32_16x16x32_bf16 v[20:23], a[228:231], v[200:203], v[20:23]
    v_mfma_f32_16x16x32_bf16 v[36:39], a[228:231], v[204:207], v[36:39]
    buffer_load_dwordx4 v9, s[24:27], s52 offen offset:2048 sc1 lds
    v_mfma_f32_16x16x32_bf16 v[52:55], a[228:231], v[208:211], v[52:55]
    v_mfma_f32_16x16x32_bf16 v[68:71], a[228:231], v[212:215], v[68:71]
    buffer_load_dwordx4 v10, s[24:27], s52 offen offset:3072 sc1 lds
    v_mfma_f32_16x16x32_bf16 v[24:27], a[232:235], v[200:203], v[24:27]
    v_mfma_f32_16x16x32_bf16 v[40:43], a[232:235], v[204:207], v[40:43]
    s_lshl_b32 s59, s41, 12
    s_add_u32 m0, s59, s47
    s_lshl_b32 s52, s41, 17
    s_add_u32 s52, s52, s46
    s_add_u32 s41, s41, 1
    s_and_b32 s41, s41, 3
    buffer_load_dwordx4 v14, s[24:27], s52 offen offset:0 sc1 lds
    v_mfma_f32_16x16x32_bf16 v[56:59], a[232:235], v[208:211], v[56:59]
    v_mfma_f32_16x16x32_bf16 v[72:75], a[232:235], v[212:215], v[72:75]
    buffer_load_dwordx4 v8, s[24:27], s52 offen offset:1024 sc1 lds
    v_mfma_f32_16x16x32_bf16 v[28:31], a[236:239], v[200:203], v[28:31]
    v_mfma_f32_16x16x32_bf16 v[44:47], a[236:239], v[204:207], v[44:47]
    buffer_load_dwordx4 v9, s[24:27], s52 offen offset:2048 sc1 lds
    v_mfma_f32_16x16x32_bf16 v[60:63], a[236:239], v[208:211], v[60:63]
    v_mfma_f32_16x16x32_bf16 v[76:79], a[236:239], v[212:215], v[76:79]
    buffer_load_dwordx4 v10, s[24:27], s52 offen offset:3072 sc1 lds
    s_waitcnt vmcnt(26)
    s_bitcmp1_b32 s36, 0
    s_cselect_b64 vcc, -1, 0
    v_cndmask_b32 v240, v120, v122, vcc
    v_cndmask_b32 v241, v122, v120, vcc
    v_cndmask_b32 v122, v124, v126, vcc
    v_cndmask_b32 v126, v126, v124, vcc
    v_mov_b32 v120, v240
    v_mov_b32 v124, v241
    v_cndmask_b32 v240, v121, v123, vcc
    v_cndmask_b32 v241, v123, v121, vcc
    v_cndmask_b32 v123, v125, v127, vcc
    v_cndmask_b32 v127, v127, v125, vcc
    v_mov_b32 v121, v240
    v_mov_b32 v125, v241
    v_cndmask_b32 v240, v128, v130, vcc
    v_cndmask_b32 v241, v130, v128, vcc
    v_cndmask_b32 v130, v132, v134, vcc
    v_cndmask_b32 v134, v134, v132, vcc
    v_mov_b32 v128, v240
    v_mov_b32 v132, v241
    v_cndmask_b32 v240, v129, v131, vcc
    v_cndmask_b32 v241, v131, v129, vcc
    v_cndmask_b32 v131, v133, v135, vcc
    v_cndmask_b32 v135, v135, v133, vcc
    v_mov_b32 v129, v240
    v_mov_b32 v133, v241
    v_mfma_f32_16x16x32_bf16 v[16:19], a[240:243], v[120:123], v[16:19]
    v_mfma_f32_16x16x32_bf16 v[32:35], a[240:243], v[124:127], v[32:35]
    s_lshl_b32 s59, s41, 12
    s_add_u32 m0, s59, s47
    s_lshl_b32 s52, s41, 17
    s_add_u32 s52, s52, s46
    s_add_u32 s41, s41, 1
    s_and_b32 s41, s41, 3
    buffer_load_dwordx4 v14, s[24:27], s52 offen offset:0 sc1 lds
    v_mfma_f32_16x16x32_bf16 v[48:51], a[240:243], v[128:131], v[48:51]
    v_mfma_f32_16x16x32_bf16 v[64:67], a[240:243], v[132:135], v[64:67]
    buffer_load_dwordx4 v8, s[24:27], s52 offen offset:1024 sc1 lds
    v_mfma_f32_16x16x32_bf16 v[20:23], a[244:247], v[120:123], v[20:23]
    v_mfma_f32_16x16x32_bf16 v[36:39], a[244:247], v[124:127], v[36:39]
    buffer_load_dwordx4 v9, s[24:27], s52 offen offset:2048 sc1 lds
    v_mfma_f32_16x16x32_bf16 v[52:55], a[244:247], v[128:131], v[52:55]
    v_mfma_f32_16x16x32_bf16 v[68:71], a[244:247], v[132:135], v[68:71]
    buffer_load_dwordx4 v10, s[24:27], s52 offen offset:3072 sc1 lds
    v_mfma_f32_16x16x32_bf16 v[24:27], a[248:251], v[120:123], v[24:27]
    v_mfma_f32_16x16x32_bf16 v[40:43], a[248:251], v[124:127], v[40:43]
    s_lshl_b32 s59, s41, 12
    s_add_u32 m0, s59, s47
    s_lshl_b32 s52, s41, 17
    s_add_u32 s52, s52, s46
    s_add_u32 s41, s41, 1
    s_and_b32 s41, s41, 3
    buffer_load_dwordx4 v14, s[24:27], s52 offen offset:0 sc1 lds
    v_mfma_f32_16x16x32_bf16 v[56:59], a[248:251], v[128:131], v[56:59]
    v_mfma_f32_16x16x32_bf16 v[72:75], a[248:251], v[132:135], v[72:75]
    buffer_load_dwordx4 v8, s[24:27], s52 offen offset:1024 sc1 lds
    v_mfma_f32_16x16x32_bf16 v[28:31], a[252:255], v[120:123], v[28:31]
    v_mfma_f32_16x16x32_bf16 v[44:47], a[252:255], v[124:127], v[44:47]
    buffer_load_dwordx4 v9, s[24:27], s52 offen offset:2048 sc1 lds
    v_mfma_f32_16x16x32_bf16 v[60:63], a[252:255], v[128:131], v[60:63]
    v_mfma_f32_16x16x32_bf16 v[76:79], a[252:255], v[132:135], v[76:79]
    buffer_load_dwordx4 v10, s[24:27], s52 offen offset:3072 sc1 lds
    s_waitcnt vmcnt(30)
    v_mfma_f32_16x16x32_bf16 v[16:19], a[16:19], v[136:139], v[16:19]
    v_mfma_f32_16x16x32_bf16 v[32:35], a[16:19], v[140:143], v[32:35]
    s_add_u32 s45, s43, 12288
    buffer_load_dwordx4 v[184:187], v13, s[24:27], s45 offen sc1
    v_mfma_f32_16x16x32_bf16 v[48:51], a[16:19], v[144:147], v[48:51]
    v_mfma_f32_16x16x32_bf16 v[64:67], a[16:19], v[148:151], v[64:67]
    buffer_load_dwordx4 v[188:191], v5, s[24:27], s45 offen sc1
    v_mfma_f32_16x16x32_bf16 v[20:23], a[20:23], v[136:139], v[20:23]
    v_mfma_f32_16x16x32_bf16 v[36:39], a[20:23], v[140:143], v[36:39]
    buffer_load_dwordx4 v[192:195], v6, s[24:27], s45 offen sc1
    v_mfma_f32_16x16x32_bf16 v[52:55], a[20:23], v[144:147], v[52:55]
    v_mfma_f32_16x16x32_bf16 v[68:71], a[20:23], v[148:151], v[68:71]
    buffer_load_dwordx4 v[196:199], v15, s[24:27], s45 offen sc1
    v_mfma_f32_16x16x32_bf16 v[24:27], a[24:27], v[136:139], v[24:27]
    v_mfma_f32_16x16x32_bf16 v[40:43], a[24:27], v[140:143], v[40:43]
    s_add_u32 s45, s43, 16384
    buffer_load_dwordx4 v[200:203], v13, s[24:27], s45 offen sc1
    v_mfma_f32_16x16x32_bf16 v[56:59], a[24:27], v[144:147], v[56:59]
    v_mfma_f32_16x16x32_bf16 v[72:75], a[24:27], v[148:151], v[72:75]
    buffer_load_dwordx4 v[204:207], v5, s[24:27], s45 offen sc1
    v_mfma_f32_16x16x32_bf16 v[28:31], a[28:31], v[136:139], v[28:31]
    v_mfma_f32_16x16x32_bf16 v[44:47], a[28:31], v[140:143], v[44:47]
    buffer_load_dwordx4 v[208:211], v6, s[24:27], s45 offen sc1
    v_mfma_f32_16x16x32_bf16 v[60:63], a[28:31], v[144:147], v[60:63]
    v_mfma_f32_16x16x32_bf16 v[76:79], a[28:31], v[148:151], v[76:79]
    buffer_load_dwordx4 v[212:215], v15, s[24:27], s45 offen sc1
    s_waitcnt vmcnt(28)
    v_mfma_f32_16x16x32_bf16 v[16:19], a[32:35], v[152:155], v[16:19]
    v_mfma_f32_16x16x32_bf16 v[32:35], a[32:35], v[156:159], v[32:35]
    s_add_u32 s45, s43, 20480
    buffer_load_dwordx4 v[120:123], v13, s[24:27], s45 offen sc1
    v_mfma_f32_16x16x32_bf16 v[48:51], a[32:35], v[160:163], v[48:51]
    v_mfma_f32_16x16x32_bf16 v[64:67], a[32:35], v[164:167], v[64:67]
    buffer_load_dwordx4 v[124:127], v5, s[24:27], s45 offen sc1
    v_mfma_f32_16x16x32_bf16 v[20:23], a[36:39], v[152:155], v[20:23]
    v_mfma_f32_16x16x32_bf16 v[36:39], a[36:39], v[156:159], v[36:39]
    buffer_load_dwordx4 v[128:131], v6, s[24:27], s45 offen sc1
    v_mfma_f32_16x16x32_bf16 v[52:55], a[36:39], v[160:163], v[52:55]
    v_mfma_f32_16x16x32_bf16 v[68:71], a[36:39], v[164:167], v[68:71]
    buffer_load_dwordx4 v[132:135], v15, s[24:27], s45 offen sc1
    v_mfma_f32_16x16x32_bf16 v[24:27], a[40:43], v[152:155], v[24:27]
    v_mfma_f32_16x16x32_bf16 v[40:43], a[40:43], v[156:159], v[40:43]
    s_add_u32 s45, s43, 24576
    buffer_load_dwordx4 v[136:139], v244, s[24:27], s45 offen sc1
    v_mfma_f32_16x16x32_bf16 v[56:59], a[40:43], v[160:163], v[56:59]
    v_mfma_f32_16x16x32_bf16 v[72:75], a[40:43], v[164:167], v[72:75]
    buffer_load_dwordx4 v[140:143], v245, s[24:27], s45 offen sc1
    v_mfma_f32_16x16x32_bf16 v[28:31], a[44:47], v[152:155], v[28:31]
    v_mfma_f32_16x16x32_bf16 v[44:47], a[44:47], v[156:159], v[44:47]
    buffer_load_dwordx4 v[144:147], v246, s[24:27], s45 offen sc1
    v_mfma_f32_16x16x32_bf16 v[60:63], a[44:47], v[160:163], v[60:63]
    v_mfma_f32_16x16x32_bf16 v[76:79], a[44:47], v[164:167], v[76:79]
    buffer_load_dwordx4 v[148:151], v247, s[24:27], s45 offen sc1
    s_waitcnt vmcnt(16) lgkmcnt(0)
    s_barrier
    ds_read_b64_tr_b16 v[216:217], v11 offset:0
    ds_read_b64_tr_b16 v[218:219], v11 offset:512
    ds_read_b128 v[224:227], v4 offset:0
    ds_read_b128 v[228:231], v4 offset:1024
    ds_read_b128 v[232:235], v4 offset:2048
    ds_read_b128 v[236:239], v4 offset:3072
    ds_read_b64_tr_b16 v[220:221], v11 offset:4096
    ds_read_b64_tr_b16 v[222:223], v11 offset:4608
    ds_read_b128 v[80:83], v4 offset:4096
    ds_read_b128 v[84:87], v4 offset:5120
    ds_read_b128 v[88:91], v4 offset:6144
    ds_read_b128 v[92:95], v4 offset:7168
    s_waitcnt vmcnt(32)
    v_mfma_f32_16x16x32_bf16 v[16:19], a[48:51], v[168:171], v[16:19]
    v_mfma_f32_16x16x32_bf16 v[32:35], a[48:51], v[172:175], v[32:35]
    v_mfma_f32_16x16x32_bf16 v[48:51], a[48:51], v[176:179], v[48:51]
    v_mfma_f32_16x16x32_bf16 v[64:67], a[48:51], v[180:183], v[64:67]
    s_waitcnt lgkmcnt(6)
    v_mfma_f32_16x16x32_bf16 v[104:107], v[224:227], v[216:219], 0
    v_mfma_f32_16x16x32_bf16 v[108:111], v[228:231], v[216:219], 0
    v_mfma_f32_16x16x32_bf16 v[112:115], v[232:235], v[216:219], 0
    v_mfma_f32_16x16x32_bf16 v[116:119], v[236:239], v[216:219], 0
    v_mfma_f32_16x16x32_bf16 v[20:23], a[52:55], v[168:171], v[20:23]
    ds_read_b64_tr_b16 v[216:217], v11 offset:8192
    ds_read_b64_tr_b16 v[218:219], v11 offset:8704
    v_mfma_f32_16x16x32_bf16 v[36:39], a[52:55], v[172:175], v[36:39]
    ds_read_b128 v[224:227], v4 offset:8192
    ds_read_b128 v[228:231], v4 offset:9216
    v_mfma_f32_16x16x32_bf16 v[52:55], a[52:55], v[176:179], v[52:55]
    ds_read_b128 v[232:235], v4 offset:10240
    ds_read_b128 v[236:239], v4 offset:11264
    v_mfma_f32_16x16x32_bf16 v[68:71], a[52:55], v[180:183], v[68:71]
    s_waitcnt lgkmcnt(6)
    v_mfma_f32_16x16x32_bf16 v[104:107], v[80:83], v[220:223], v[104:107]
    v_mfma_f32_16x16x32_bf16 v[108:111], v[84:87], v[220:223], v[108:111]
    v_mfma_f32_16x16x32_bf16 v[112:115], v[88:91], v[220:223], v[112:115]
    v_mfma_f32_16x16x32_bf16 v[116:119], v[92:95], v[220:223], v[116:119]
    v_mfma_f32_16x16x32_bf16 v[24:27], a[56:59], v[168:171], v[24:27]
    ds_read_b64_tr_b16 v[220:221], v11 offset:12288
    ds_read_b64_tr_b16 v[222:223], v11 offset:12800
    v_mfma_f32_16x16x32_bf16 v[40:43], a[56:59], v[172:175], v[40:43]
    ds_read_b128 v[80:83], v4 offset:12288
    ds_read_b128 v[84:87], v4 offset:13312
    v_mfma_f32_16x16x32_bf16 v[56:59], a[56:59], v[176:179], v[56:59]
    ds_read_b128 v[88:91], v4 offset:14336
    ds_read_b128 v[92:95], v4 offset:15360
    v_mfma_f32_16x16x32_bf16 v[72:75], a[56:59], v[180:183], v[72:75]
    s_waitcnt lgkmcnt(6)
    v_mfma_f32_16x16x32_bf16 v[104:107], v[224:227], v[216:219], v[104:107]
    v_mfma_f32_16x16x32_bf16 v[108:111], v[228:231], v[216:219], v[108:111]
    v_mfma_f32_16x16x32_bf16 v[112:115], v[232:235], v[216:219], v[112:115]
    v_mfma_f32_16x16x32_bf16 v[116:119], v[236:239], v[216:219], v[116:119]
    v_mfma_f32_16x16x32_bf16 v[28:31], a[60:63], v[168:171], v[28:31]
    ds_read_b64_tr_b16 v[216:217], v11 offset:16384
    ds_read_b64_tr_b16 v[218:219], v11 offset:16896
    v_mfma_f32_16x16x32_bf16 v[44:47], a[60:63], v[172:175], v[44:47]
    ds_read_b128 v[224:227], v4 offset:16384
    ds_read_b128 v[228:231], v4 offset:17408
    v_mfma_f32_16x16x32_bf16 v[60:63], a[60:63], v[176:179], v[60:63]
    ds_read_b128 v[232:235], v4 offset:18432
    ds_read_b128 v[236:239], v4 offset:19456
    v_mfma_f32_16x16x32_bf16 v[76:79], a[60:63], v[180:183], v[76:79]
    s_waitcnt lgkmcnt(6)
    v_mfma_f32_16x16x32_bf16 v[104:107], v[80:83], v[220:223], v[104:107]
    v_mfma_f32_16x16x32_bf16 v[108:111], v[84:87], v[220:223], v[108:111]
    v_mfma_f32_16x16x32_bf16 v[112:115], v[88:91], v[220:223], v[112:115]
    v_mfma_f32_16x16x32_bf16 v[116:119], v[92:95], v[220:223], v[116:119]
    s_waitcnt vmcnt(12)
    v_mfma_f32_16x16x32_bf16 v[16:19], a[64:67], v[184:187], v[16:19]
    ds_read_b64_tr_b16 v[220:221], v11 offset:20480
    ds_read_b64_tr_b16 v[222:223], v11 offset:20992
    v_mfma_f32_16x16x32_bf16 v[32:35], a[64:67], v[188:191], v[32:35]
    ds_read_b128 v[80:83], v4 offset:20480
    ds_read_b128 v[84:87], v4 offset:21504
    v_mfma_f32_16x16x32_bf16 v[48:51], a[64:67], v[192:195], v[48:51]
    ds_read_b128 v[88:91], v4 offset:22528
    ds_read_b128 v[92:95], v4 offset:23552
    v_mfma_f32_16x16x32_bf16 v[64:67], a[64:67], v[196:199], v[64:67]
    s_waitcnt lgkmcnt(6)
    v_mfma_f32_16x16x32_bf16 v[104:107], v[224:227], v[216:219], v[104:107]
    v_mfma_f32_16x16x32_bf16 v[108:111], v[228:231], v[216:219], v[108:111]
    v_mfma_f32_16x16x32_bf16 v[112:115], v[232:235], v[216:219], v[112:115]
    v_mfma_f32_16x16x32_bf16 v[116:119], v[236:239], v[216:219], v[116:119]
    v_mfma_f32_16x16x32_bf16 v[20:23], a[68:71], v[184:187], v[20:23]
    ds_read_b64_tr_b16 v[216:217], v11 offset:24576
    ds_read_b64_tr_b16 v[218:219], v11 offset:25088
    v_mfma_f32_16x16x32_bf16 v[36:39], a[68:71], v[188:191], v[36:39]
    ds_read_b128 v[224:227], v4 offset:24576
    ds_read_b128 v[228:231], v4 offset:25600
    v_mfma_f32_16x16x32_bf16 v[52:55], a[68:71], v[192:195], v[52:55]
    ds_read_b128 v[232:235], v4 offset:26624
    ds_read_b128 v[236:239], v4 offset:27648
    v_mfma_f32_16x16x32_bf16 v[68:71], a[68:71], v[196:199], v[68:71]
    s_waitcnt lgkmcnt(6)
    v_mfma_f32_16x16x32_bf16 v[104:107], v[80:83], v[220:223], v[104:107]
    v_mfma_f32_16x16x32_bf16 v[108:111], v[84:87], v[220:223], v[108:111]
    v_mfma_f32_16x16x32_bf16 v[112:115], v[88:91], v[220:223], v[112:115]
    v_mfma_f32_16x16x32_bf16 v[116:119], v[92:95], v[220:223], v[116:119]
    v_mfma_f32_16x16x32_bf16 v[24:27], a[72:75], v[184:187], v[24:27]
    ds_read_b64_tr_b16 v[220:221], v11 offset:28672
    ds_read_b64_tr_b16 v[222:223], v11 offset:29184
    v_mfma_f32_16x16x32_bf16 v[40:43], a[72:75], v[188:191], v[40:43]
    ds_read_b128 v[80:83], v4 offset:28672
    ds_read_b128 v[84:87], v4 offset:29696
    v_mfma_f32_16x16x32_bf16 v[56:59], a[72:75], v[192:195], v[56:59]
    ds_read_b128 v[88:91], v4 offset:30720
    ds_read_b128 v[92:95], v4 offset:31744
    v_mfma_f32_16x16x32_bf16 v[72:75], a[72:75], v[196:199], v[72:75]
    s_waitcnt lgkmcnt(6)
    v_mfma_f32_16x16x32_bf16 v[104:107], v[224:227], v[216:219], v[104:107]
    v_mfma_f32_16x16x32_bf16 v[108:111], v[228:231], v[216:219], v[108:111]
    v_mfma_f32_16x16x32_bf16 v[112:115], v[232:235], v[216:219], v[112:115]
    v_mfma_f32_16x16x32_bf16 v[116:119], v[236:239], v[216:219], v[116:119]
    v_mfma_f32_16x16x32_bf16 v[28:31], a[76:79], v[184:187], v[28:31]
    ds_read_b64_tr_b16 v[216:217], v11 offset:32768
    ds_read_b64_tr_b16 v[218:219], v11 offset:33280
    v_mfma_f32_16x16x32_bf16 v[44:47], a[76:79], v[188:191], v[44:47]
    ds_read_b128 v[224:227], v4 offset:32768
    ds_read_b128 v[228:231], v4 offset:33792
    v_mfma_f32_16x16x32_bf16 v[60:63], a[76:79], v[192:195], v[60:63]
    ds_read_b128 v[232:235], v4 offset:34816
    ds_read_b128 v[236:239], v4 offset:35840
    v_mfma_f32_16x16x32_bf16 v[76:79], a[76:79], v[196:199], v[76:79]
    s_waitcnt lgkmcnt(6)
    v_mfma_f32_16x16x32_bf16 v[104:107], v[80:83], v[220:223], v[104:107]
    v_mfma_f32_16x16x32_bf16 v[108:111], v[84:87], v[220:223], v[108:111]
    v_mfma_f32_16x16x32_bf16 v[112:115], v[88:91], v[220:223], v[112:115]
    v_mfma_f32_16x16x32_bf16 v[116:119], v[92:95], v[220:223], v[116:119]
    s_waitcnt vmcnt(8)
    v_mfma_f32_16x16x32_bf16 v[16:19], a[80:83], v[200:203], v[16:19]
    ds_read_b64_tr_b16 v[220:221], v11 offset:36864
    ds_read_b64_tr_b16 v[222:223], v11 offset:37376
    v_mfma_f32_16x16x32_bf16 v[32:35], a[80:83], v[204:207], v[32:35]
    ds_read_b128 v[80:83], v4 offset:36864
    ds_read_b128 v[84:87], v4 offset:37888
    v_mfma_f32_16x16x32_bf16 v[48:51], a[80:83], v[208:211], v[48:51]
    ds_read_b128 v[88:91], v4 offset:38912
    ds_read_b128 v[92:95], v4 offset:39936
    v_mfma_f32_16x16x32_bf16 v[64:67], a[80:83], v[212:215], v[64:67]
    s_waitcnt lgkmcnt(6)
    v_mfma_f32_16x16x32_bf16 v[104:107], v[224:227], v[216:219], v[104:107]
    v_mfma_f32_16x16x32_bf16 v[108:111], v[228:231], v[216:219], v[108:111]
    v_mfma_f32_16x16x32_bf16 v[112:115], v[232:235], v[216:219], v[112:115]
    v_mfma_f32_16x16x32_bf16 v[116:119], v[236:239], v[216:219], v[116:119]
    v_mfma_f32_16x16x32_bf16 v[20:23], a[84:87], v[200:203], v[20:23]
    ds_read_b64_tr_b16 v[216:217], v11 offset:40960
    ds_read_b64_tr_b16 v[218:219], v11 offset:41472
    v_mfma_f32_16x16x32_bf16 v[36:39], a[84:87], v[204:207], v[36:39]
    ds_read_b128 v[224:227], v4 offset:40960
    ds_read_b128 v[228:231], v4 offset:41984
    v_mfma_f32_16x16x32_bf16 v[52:55], a[84:87], v[208:211], v[52:55]
    ds_read_b128 v[232:235], v4 offset:43008
    ds_read_b128 v[236:239], v4 offset:44032
    v_mfma_f32_16x16x32_bf16 v[68:71], a[84:87], v[212:215], v[68:71]
    s_waitcnt lgkmcnt(6)
    v_mfma_f32_16x16x32_bf16 v[104:107], v[80:83], v[220:223], v[104:107]
    v_mfma_f32_16x16x32_bf16 v[108:111], v[84:87], v[220:223], v[108:111]
    v_mfma_f32_16x16x32_bf16 v[112:115], v[88:91], v[220:223], v[112:115]
    v_mfma_f32_16x16x32_bf16 v[116:119], v[92:95], v[220:223], v[116:119]
    v_mfma_f32_16x16x32_bf16 v[24:27], a[88:91], v[200:203], v[24:27]
    ds_read_b64_tr_b16 v[220:221], v11 offset:45056
    ds_read_b64_tr_b16 v[222:223], v11 offset:45568
    v_mfma_f32_16x16x32_bf16 v[40:43], a[88:91], v[204:207], v[40:43]
    ds_read_b128 v[80:83], v4 offset:45056
    ds_read_b128 v[84:87], v4 offset:46080
    v_mfma_f32_16x16x32_bf16 v[56:59], a[88:91], v[208:211], v[56:59]
    ds_read_b128 v[88:91], v4 offset:47104
    ds_read_b128 v[92:95], v4 offset:48128
    v_mfma_f32_16x16x32_bf16 v[72:75], a[88:91], v[212:215], v[72:75]
    s_waitcnt lgkmcnt(6)
    v_mfma_f32_16x16x32_bf16 v[104:107], v[224:227], v[216:219], v[104:107]
    v_mfma_f32_16x16x32_bf16 v[108:111], v[228:231], v[216:219], v[108:111]
    v_mfma_f32_16x16x32_bf16 v[112:115], v[232:235], v[216:219], v[112:115]
    v_mfma_f32_16x16x32_bf16 v[116:119], v[236:239], v[216:219], v[116:119]
    v_mfma_f32_16x16x32_bf16 v[28:31], a[92:95], v[200:203], v[28:31]
    ds_read_b64_tr_b16 v[216:217], v11 offset:49152
    ds_read_b64_tr_b16 v[218:219], v11 offset:49664
    v_mfma_f32_16x16x32_bf16 v[44:47], a[92:95], v[204:207], v[44:47]
    ds_read_b128 v[224:227], v4 offset:49152
    ds_read_b128 v[228:231], v4 offset:50176
    v_mfma_f32_16x16x32_bf16 v[60:63], a[92:95], v[208:211], v[60:63]
    ds_read_b128 v[232:235], v4 offset:51200
    ds_read_b128 v[236:239], v4 offset:52224
    v_mfma_f32_16x16x32_bf16 v[76:79], a[92:95], v[212:215], v[76:79]
    s_waitcnt lgkmcnt(6)
    v_mfma_f32_16x16x32_bf16 v[104:107], v[80:83], v[220:223], v[104:107]
    v_mfma_f32_16x16x32_bf16 v[108:111], v[84:87], v[220:223], v[108:111]
    v_mfma_f32_16x16x32_bf16 v[112:115], v[88:91], v[220:223], v[112:115]
    v_mfma_f32_16x16x32_bf16 v[116:119], v[92:95], v[220:223], v[116:119]
    s_waitcnt vmcnt(4)
    v_mfma_f32_16x16x32_bf16 v[16:19], a[96:99], v[120:123], v[16:19]
    ds_read_b64_tr_b16 v[220:221], v11 offset:53248
    ds_read_b64_tr_b16 v[222:223], v11 offset:53760
    v_mfma_f32_16x16x32_bf16 v[32:35], a[96:99], v[124:127], v[32:35]
    ds_read_b128 v[80:83], v4 offset:53248
    ds_read_b128 v[84:87], v4 offset:54272
    v_mfma_f32_16x16x32_bf16 v[48:51], a[96:99], v[128:131], v[48:51]
    ds_read_b128 v[88:91], v4 offset:55296
    ds_read_b128 v[92:95], v4 offset:56320
    v_mfma_f32_16x16x32_bf16 v[64:67], a[96:99], v[132:135], v[64:67]
    s_waitcnt lgkmcnt(6)
    v_mfma_f32_16x16x32_bf16 v[104:107], v[224:227], v[216:219], v[104:107]
    v_mfma_f32_16x16x32_bf16 v[108:111], v[228:231], v[216:219], v[108:111]
    v_mfma_f32_16x16x32_bf16 v[112:115], v[232:235], v[216:219], v[112:115]
    v_mfma_f32_16x16x32_bf16 v[116:119], v[236:239], v[216:219], v[116:119]
    v_mfma_f32_16x16x32_bf16 v[20:23], a[100:103], v[120:123], v[20:23]
    ds_read_b64_tr_b16 v[216:217], v11 offset:57344
    ds_read_b64_tr_b16 v[218:219], v11 offset:57856
    v_mfma_f32_16x16x32_bf16 v[36:39], a[100:103], v[124:127], v[36:39]
    ds_read_b128 v[224:227], v4 offset:57344
    ds_read_b128 v[228:231], v4 offset:58368
    v_mfma_f32_16x16x32_bf16 v[52:55], a[100:103], v[128:131], v[52:55]
    ds_read_b128 v[232:235], v4 offset:59392
    ds_read_b128 v[236:239], v4 offset:60416
    v_mfma_f32_16x16x32_bf16 v[68:71], a[100:103], v[132:135], v[68:71]
    s_waitcnt lgkmcnt(6)
    v_mfma_f32_16x16x32_bf16 v[104:107], v[80:83], v[220:223], v[104:107]
    v_mfma_f32_16x16x32_bf16 v[108:111], v[84:87], v[220:223], v[108:111]
    v_mfma_f32_16x16x32_bf16 v[112:115], v[88:91], v[220:223], v[112:115]
    v_mfma_f32_16x16x32_bf16 v[116:119], v[92:95], v[220:223], v[116:119]
    v_mfma_f32_16x16x32_bf16 v[24:27], a[104:107], v[120:123], v[24:27]
    ds_read_b64_tr_b16 v[220:221], v11 offset:61440
    ds_read_b64_tr_b16 v[222:223], v11 offset:61952
    v_mfma_f32_16x16x32_bf16 v[40:43], a[104:107], v[124:127], v[40:43]
    ds_read_b128 v[80:83], v4 offset:61440
    ds_read_b128 v[84:87], v4 offset:62464
    v_mfma_f32_16x16x32_bf16 v[56:59], a[104:107], v[128:131], v[56:59]
    ds_read_b128 v[88:91], v4 offset:63488
    ds_read_b128 v[92:95], v4 offset:64512
    v_mfma_f32_16x16x32_bf16 v[72:75], a[104:107], v[132:135], v[72:75]
    s_waitcnt lgkmcnt(6)
    v_mfma_f32_16x16x32_bf16 v[104:107], v[224:227], v[216:219], v[104:107]
    v_mfma_f32_16x16x32_bf16 v[108:111], v[228:231], v[216:219], v[108:111]
    v_mfma_f32_16x16x32_bf16 v[112:115], v[232:235], v[216:219], v[112:115]
    v_mfma_f32_16x16x32_bf16 v[116:119], v[236:239], v[216:219], v[116:119]
    v_mfma_f32_16x16x32_bf16 v[28:31], a[108:111], v[120:123], v[28:31]
    v_mfma_f32_16x16x32_bf16 v[44:47], a[108:111], v[124:127], v[44:47]
    v_mfma_f32_16x16x32_bf16 v[60:63], a[108:111], v[128:131], v[60:63]
    v_mfma_f32_16x16x32_bf16 v[76:79], a[108:111], v[132:135], v[76:79]
    s_waitcnt lgkmcnt(0)
    v_mfma_f32_16x16x32_bf16 v[104:107], v[80:83], v[220:223], v[104:107]
    v_mfma_f32_16x16x32_bf16 v[108:111], v[84:87], v[220:223], v[108:111]
    v_mfma_f32_16x16x32_bf16 v[112:115], v[88:91], v[220:223], v[112:115]
    v_mfma_f32_16x16x32_bf16 v[116:119], v[92:95], v[220:223], v[116:119]
    s_barrier
    s_waitcnt vmcnt(0)
    s_bitcmp1_b32 s36, 0
    s_cselect_b64 vcc, -1, 0
    v_cndmask_b32 v240, v136, v138, vcc
    v_cndmask_b32 v241, v138, v136, vcc
    v_cndmask_b32 v138, v140, v142, vcc
    v_cndmask_b32 v142, v142, v140, vcc
    v_mov_b32 v136, v240
    v_mov_b32 v140, v241
    v_cndmask_b32 v240, v137, v139, vcc
    v_cndmask_b32 v241, v139, v137, vcc
    v_cndmask_b32 v139, v141, v143, vcc
    v_cndmask_b32 v143, v143, v141, vcc
    v_mov_b32 v137, v240
    v_mov_b32 v141, v241
    v_cndmask_b32 v240, v144, v146, vcc
    v_cndmask_b32 v241, v146, v144, vcc
    v_cndmask_b32 v146, v148, v150, vcc
    v_cndmask_b32 v150, v150, v148, vcc
    v_mov_b32 v144, v240
    v_mov_b32 v148, v241
    v_cndmask_b32 v240, v145, v147, vcc
    v_cndmask_b32 v241, v147, v145, vcc
    v_cndmask_b32 v147, v149, v151, vcc
    v_cndmask_b32 v151, v151, v149, vcc
    v_mov_b32 v145, v240
    v_mov_b32 v149, v241
    v_mfma_f32_16x16x32_bf16 v[32:35], a[112:115], v[140:143], v[32:35]
    ds_read_b64 v[216:217], v248
    ds_read_b64 v[218:219], v249
    v_mfma_f32_16x16x32_bf16 v[36:39], a[116:119], v[140:143], v[36:39]
    ds_read_b64 v[220:221], v250
    ds_read_b64 v[222:223], v251
    v_mfma_f32_16x16x32_bf16 v[40:43], a[120:123], v[140:143], v[40:43]
    v_cvt_pk_bf16_f32 v100, v104, v105
    v_lshlrev_b32 v104, 16, v100
    v_mfma_f32_16x16x32_bf16 v[44:47], a[124:127], v[140:143], v[44:47]
    v_and_b32 v105, 0xffff0000, v100
    v_cvt_pk_bf16_f32 v100, v106, v107
    v_mfma_f32_16x16x32_bf16 v[48:51], a[112:115], v[144:147], v[48:51]
    v_lshlrev_b32 v106, 16, v100
    v_and_b32 v107, 0xffff0000, v100
    v_mfma_f32_16x16x32_bf16 v[52:55], a[116:119], v[144:147], v[52:55]
    v_cvt_pk_bf16_f32 v100, v108, v109
    v_lshlrev_b32 v108, 16, v100
    v_mfma_f32_16x16x32_bf16 v[56:59], a[120:123], v[144:147], v[56:59]
    ds_write_b128 v96, v[32:35] offset:0
    ds_write_b128 v96, v[36:39] offset:1024
    v_mfma_f32_16x16x32_bf16 v[60:63], a[124:127], v[144:147], v[60:63]
    ds_write_b128 v96, v[40:43] offset:2048
    ds_write_b128 v96, v[44:47] offset:3072
    v_mfma_f32_16x16x32_bf16 v[64:67], a[112:115], v[148:151], v[64:67]
    v_and_b32 v109, 0xffff0000, v100
    v_cvt_pk_bf16_f32 v100, v110, v111
    v_mfma_f32_16x16x32_bf16 v[68:71], a[116:119], v[148:151], v[68:71]
    v_lshlrev_b32 v110, 16, v100
    v_and_b32 v111, 0xffff0000, v100
    v_mfma_f32_16x16x32_bf16 v[72:75], a[120:123], v[148:151], v[72:75]
    ds_write_b128 v96, v[48:51] offset:4096
    ds_write_b128 v96, v[52:55] offset:5120
    v_mfma_f32_16x16x32_bf16 v[76:79], a[124:127], v[148:151], v[76:79]
    ds_write_b128 v96, v[56:59] offset:6144
    ds_write_b128 v96, v[60:63] offset:7168
    v_mfma_f32_16x16x32_bf16 v[16:19], a[112:115], v[136:139], v[16:19]
    v_cvt_pk_bf16_f32 v100, v112, v113
    v_lshlrev_b32 v112, 16, v100
    v_mfma_f32_16x16x32_bf16 v[20:23], a[116:119], v[136:139], v[20:23]
    v_and_b32 v113, 0xffff0000, v100
    v_cvt_pk_bf16_f32 v100, v114, v115
    v_mfma_f32_16x16x32_bf16 v[24:27], a[120:123], v[136:139], v[24:27]
    ds_write_b128 v96, v[64:67] offset:8192
    ds_write_b128 v96, v[68:71] offset:9216
    v_mfma_f32_16x16x32_bf16 v[28:31], a[124:127], v[136:139], v[28:31]
    ds_write_b128 v96, v[72:75] offset:10240
    ds_write_b128 v96, v[76:79] offset:11264
    v_lshlrev_b32 v114, 16, v100
    v_and_b32 v115, 0xffff0000, v100
    v_cvt_pk_bf16_f32 v100, v116, v117
    v_lshlrev_b32 v116, 16, v100
    v_and_b32 v117, 0xffff0000, v100
    v_cvt_pk_bf16_f32 v100, v118, v119
    v_lshlrev_b32 v118, 16, v100
    v_and_b32 v119, 0xffff0000, v100
    s_waitcnt lgkmcnt(12)
    v_lshlrev_b32 v224, 16, v216
    v_and_b32 v225, 0xffff0000, v216
    v_lshlrev_b32 v226, 16, v217
    v_and_b32 v227, 0xffff0000, v217
    v_lshlrev_b32 v228, 16, v218
    v_and_b32 v229, 0xffff0000, v218
    v_lshlrev_b32 v230, 16, v219
    v_and_b32 v231, 0xffff0000, v219
    v_lshlrev_b32 v232, 16, v220
    v_and_b32 v233, 0xffff0000, v220
    v_lshlrev_b32 v234, 16, v221
    v_and_b32 v235, 0xffff0000, v221
    v_lshlrev_b32 v236, 16, v222
    v_and_b32 v237, 0xffff0000, v222
    v_lshlrev_b32 v238, 16, v223
    v_and_b32 v239, 0xffff0000, v223
    s_mov_b32 s54, 0xbfb8aa3b
    s_mov_b32 s55, s54
    s_mov_b32 s56, 1.0
    s_mov_b32 s57, 1.0
    s_waitcnt lgkmcnt(0)
    s_barrier
    ds_read_b128 v[32:35], v97 offset:0
    ds_read_b128 v[36:39], v97 offset:1024
    ds_read_b128 v[40:43], v97 offset:2048
    ds_read_b128 v[44:47], v97 offset:3072
    ds_read_b128 v[48:51], v98 offset:0
    ds_read_b128 v[52:55], v98 offset:1024
    ds_read_b128 v[56:59], v98 offset:2048
    ds_read_b128 v[60:63], v98 offset:3072
    ds_read_b128 v[64:67], v99 offset:0
    ds_read_b128 v[68:71], v99 offset:1024
    ds_read_b128 v[72:75], v99 offset:2048
    ds_read_b128 v[76:79], v99 offset:3072
    s_waitcnt lgkmcnt(8)
    v_pk_add_f32 v[16:17], v[16:17], v[32:33]
    v_pk_add_f32 v[18:19], v[18:19], v[34:35]
    v_pk_add_f32 v[20:21], v[20:21], v[36:37]
    v_pk_add_f32 v[22:23], v[22:23], v[38:39]
    v_pk_add_f32 v[24:25], v[24:25], v[40:41]
    v_pk_add_f32 v[26:27], v[26:27], v[42:43]
    v_pk_add_f32 v[28:29], v[28:29], v[44:45]
    v_pk_add_f32 v[30:31], v[30:31], v[46:47]
    s_waitcnt lgkmcnt(4)
    v_pk_add_f32 v[16:17], v[16:17], v[48:49]
    v_pk_add_f32 v[18:19], v[18:19], v[50:51]
    v_pk_add_f32 v[20:21], v[20:21], v[52:53]
    v_pk_add_f32 v[22:23], v[22:23], v[54:55]
    v_pk_add_f32 v[24:25], v[24:25], v[56:57]
    v_pk_add_f32 v[26:27], v[26:27], v[58:59]
    v_pk_add_f32 v[28:29], v[28:29], v[60:61]
    v_pk_add_f32 v[30:31], v[30:31], v[62:63]
    s_waitcnt lgkmcnt(0)
    v_pk_add_f32 v[16:17], v[16:17], v[64:65]
    v_pk_add_f32 v[18:19], v[18:19], v[66:67]
    v_pk_add_f32 v[20:21], v[20:21], v[68:69]
    v_pk_add_f32 v[22:23], v[22:23], v[70:71]
    v_pk_add_f32 v[24:25], v[24:25], v[72:73]
    v_pk_add_f32 v[26:27], v[26:27], v[74:75]
    v_pk_add_f32 v[28:29], v[28:29], v[76:77]
    v_pk_add_f32 v[30:31], v[30:31], v[78:79]
    v_pk_mul_f32 v[32:33], v[16:17], s[54:55]
    v_pk_mul_f32 v[34:35], v[18:19], s[54:55]
    v_pk_mul_f32 v[36:37], v[20:21], s[54:55]
    v_pk_mul_f32 v[38:39], v[22:23], s[54:55]
    v_pk_mul_f32 v[40:41], v[24:25], s[54:55]
    v_pk_mul_f32 v[42:43], v[26:27], s[54:55]
    v_pk_mul_f32 v[44:45], v[28:29], s[54:55]
    v_pk_mul_f32 v[46:47], v[30:31], s[54:55]
    v_exp_f32 v32, v32
    v_exp_f32 v33, v33
    v_exp_f32 v34, v34
    v_exp_f32 v35, v35
    v_exp_f32 v36, v36
    v_exp_f32 v37, v37
    v_exp_f32 v38, v38
    v_exp_f32 v39, v39
    v_exp_f32 v40, v40
    v_exp_f32 v41, v41
    v_exp_f32 v42, v42
    v_exp_f32 v43, v43
    v_exp_f32 v44, v44
    v_exp_f32 v45, v45
    v_exp_f32 v46, v46
    v_exp_f32 v47, v47
    v_pk_add_f32 v[32:33], v[32:33], s[56:57]
    v_pk_add_f32 v[34:35], v[34:35], s[56:57]
    v_pk_add_f32 v[36:37], v[36:37], s[56:57]
    v_pk_add_f32 v[38:39], v[38:39], s[56:57]
    v_pk_add_f32 v[40:41], v[40:41], s[56:57]
    v_pk_add_f32 v[42:43], v[42:43], s[56:57]
    v_pk_add_f32 v[44:45], v[44:45], s[56:57]
    v_pk_add_f32 v[46:47], v[46:47], s[56:57]
    v_pk_mul_f32 v[16:17], v[16:17], v[104:105]
    v_pk_mul_f32 v[18:19], v[18:19], v[106:107]
    v_pk_mul_f32 v[20:21], v[20:21], v[108:109]
    v_pk_mul_f32 v[22:23], v[22:23], v[110:111]
    v_pk_mul_f32 v[24:25], v[24:25], v[112:113]
    v_pk_mul_f32 v[26:27], v[26:27], v[114:115]
    v_pk_mul_f32 v[28:29], v[28:29], v[116:117]
    v_pk_mul_f32 v[30:31], v[30:31], v[118:119]
    v_rcp_f32 v32, v32
    v_rcp_f32 v33, v33
    v_rcp_f32 v34, v34
    v_rcp_f32 v35, v35
    v_rcp_f32 v36, v36
    v_rcp_f32 v37, v37
    v_rcp_f32 v38, v38
    v_rcp_f32 v39, v39
    v_rcp_f32 v40, v40
    v_rcp_f32 v41, v41
    v_rcp_f32 v42, v42
    v_rcp_f32 v43, v43
    v_rcp_f32 v44, v44
    v_rcp_f32 v45, v45
    v_rcp_f32 v46, v46
    v_rcp_f32 v47, v47
    v_pk_fma_f32 v[32:33], v[32:33], v[16:17], v[224:225]
    v_pk_fma_f32 v[34:35], v[34:35], v[18:19], v[226:227]
    v_pk_fma_f32 v[36:37], v[36:37], v[20:21], v[228:229]
    v_pk_fma_f32 v[38:39], v[38:39], v[22:23], v[230:231]
    v_pk_fma_f32 v[40:41], v[40:41], v[24:25], v[232:233]
    v_pk_fma_f32 v[42:43], v[42:43], v[26:27], v[234:235]
    v_pk_fma_f32 v[44:45], v[44:45], v[28:29], v[236:237]
    v_pk_fma_f32 v[46:47], v[46:47], v[30:31], v[238:239]
    v_cvt_pk_bf16_f32 v80, v32, v33
    v_cvt_pk_bf16_f32 v81, v34, v35
    ds_write_b64 v248, v[80:81]
    v_cvt_pk_bf16_f32 v82, v36, v37
    v_cvt_pk_bf16_f32 v83, v38, v39
    ds_write_b64 v249, v[82:83]
    v_cvt_pk_bf16_f32 v84, v40, v41
    v_cvt_pk_bf16_f32 v85, v42, v43
    ds_write_b64 v250, v[84:85]
    v_cvt_pk_bf16_f32 v86, v44, v45
    v_cvt_pk_bf16_f32 v87, v46, v47
    ds_write_b64 v251, v[86:87]
    s_waitcnt lgkmcnt(0)
    ds_read_b128 v[88:91], v12
    ds_read_b128 v[92:95], v253 offset:1024
    s_waitcnt lgkmcnt(1)
    buffer_store_dwordx4 v[88:91], v7, s[28:31], s48 offen
    s_waitcnt lgkmcnt(0)
    buffer_store_dwordx4 v[92:95], v7, s[28:31], s49 offen
L_end:
    s_endpgm
.section .rodata,"a"
.p2align 6
.amdhsa_kernel recurrent_scan__spectral_gfnet__dense_activation_silu__prompt_kernel
  .amdhsa_next_free_vgpr 512
  .amdhsa_next_free_sgpr 102
  .amdhsa_accum_offset 256
  .amdhsa_group_segment_fixed_size 0
  .amdhsa_kernarg_size 72
  .amdhsa_user_sgpr_count 2
  .amdhsa_user_sgpr_kernarg_segment_ptr 1
  .amdhsa_system_sgpr_workgroup_id_x 1
  .amdhsa_float_denorm_mode_32 3
  .amdhsa_float_denorm_mode_16_64 3
.end_amdhsa_kernel
```
